```python
import torch

def _softmax(x, axis=-1):
    return torch.softmax(x, dim=axis)
def _gelu(x):
    return torch.nn.functional.gelu(x, approximate="tanh")
def _silu(x):
    return torch.nn.functional.silu(x)
def _sigmoid(x):
    return torch.sigmoid(x)
def _layernorm(x, axis=-1, eps=1e-5):
    m = x.mean(dim=axis, keepdim=True)
    v = x.var(dim=axis, keepdim=True, unbiased=False)
    return (x - m) / torch.sqrt(v + eps)
def _scatter_add(tgt, idx, src, axis=0):
    return tgt.clone().index_add_(axis, idx, src)
def _segment_sum(src, seg, n):
    out = torch.zeros((n,) + src.shape[1:], dtype=src.dtype)
    return out.index_add_(0, seg, src)
def _pad(x, pw):
    flat = tuple(v for pair in reversed(pw) for v in pair)
    return torch.nn.functional.pad(x, flat)

kernel_name = 'sequential_preLN__mha_block__dense_activation_silu__prompt'

def setup_inputs():

    _w = (lambda a: (lambda t: t.to(torch.bfloat16) if t.is_floating_point() else t)(torch.as_tensor(a)))
    def _A_setup():
        B, S, D, H = 1, 2048, 448, 16
        return {
            "x": _w((lambda *s: torch.randn(*s, dtype=torch.bfloat16) * 0.05)(B, S, D)),
            "wqkv": _w((lambda *s: torch.randn(*s, dtype=torch.bfloat16) * 0.05)(D, 3 * D)),
            "wo": _w((lambda *s: torch.randn(*s, dtype=torch.bfloat16) * 0.05)(D, D)),
        }
    _A_in = _A_setup()

    def _B_setup():
        B, S, D, F = 1, 2048, 448, 1792
        return {
            "x": _w((lambda *s: torch.randn(*s, dtype=torch.bfloat16) * 0.05)(B, S, D)),
            "w1": _w((lambda *s: torch.randn(*s, dtype=torch.bfloat16) * 0.8)(D, F) * (D ** -0.5)),
            "w2": _w((lambda *s: torch.randn(*s, dtype=torch.bfloat16) * 0.2)(F, D) * (F ** -0.5)),
        }
    _B_in = _B_setup()

    return {
        "A_x": _A_in["x"],
        "A_wqkv": _A_in["wqkv"],
        "A_wo": _A_in["wo"],
        "B_x": _B_in["x"],
        "B_w1": _B_in["w1"],
        "B_w2": _B_in["w2"],
    }

def reference(A_x, A_wqkv, A_wo, B_x, B_w1, B_w2):
    def _A_ref(x, wqkv, wo):
        B, S, D = x.shape
        H = 16
        Dh = D // H
        qkv = (lambda x, *d: x.permute(*d))((x @ wqkv).reshape(B, S, 3, H, Dh), 2, 0, 3, 1, 4)
        q, k, v = qkv[0], qkv[1], qkv[2]
        scores = torch.einsum("bhqd,bhkd->bhqk", q, k) * (Dh ** -0.5)
        p = _softmax(scores, axis=-1)
        o = torch.einsum("bhqk,bhkd->bhqd", p, v)
        return (lambda x, *d: x.permute(*d))(o, 0, 2, 1, 3).reshape(B, S, D) @ wo

    def _B_ref(x, w1, w2):
        h = torch.einsum("bsd,df->bsf", x, w1)
        h = _silu(h)
        out = torch.einsum("bsf,fd->bsd", h, w2)
        return out

    x = A_x
    h = x + _A_ref(_layernorm(x, axis=-1), A_wqkv, A_wo)
    h2 = h + _B_ref(_layernorm(h, axis=-1), B_w1, B_w2)
    return h2
```

```asm
; @launch grid=(256,1,1) block=(256,1,1) lds=163840
.amdgcn_target "amdgcn-amd-amdhsa--gfx950"
.text
.globl sequential_preLN__mha_block__dense_activation_silu__prompt_kernel
.p2align 8
.type sequential_preLN__mha_block__dense_activation_silu__prompt_kernel,@function
sequential_preLN__mha_block__dense_activation_silu__prompt_kernel:
  s_cmp_ge_u32 s2, 256
  s_cbranch_scc1 L_end
  s_load_dwordx16 s[4:19], s[0:1], 0
  s_load_dwordx2 s[20:21], s[0:1], 64
  s_memrealtime s[40:41]
  v_lshrrev_b32 v1, 6, v0
  v_and_b32 v0, 63, v0
  v_readfirstlane_b32 s3, v1
  v_lshlrev_b32 v2, 4, v0
  v_lshlrev_b32 v1, 3, v0
  s_and_b32 s36, s2, 7
  s_lshr_b32 s37, s2, 3
  s_and_b32 s38, s36, 3
  s_lshl_b32 s38, s38, 2
  s_and_b32 s50, s37, 3
  s_add_u32 s38, s38, s50
  s_lshr_b32 s39, s36, 2
  s_lshl_b32 s39, s39, 3
  s_lshr_b32 s51, s37, 2
  s_add_u32 s39, s39, s51
  s_mul_i32 s50, s50, 2
  s_mul_i32 s51, s51, 1
  s_add_u32 s50, s50, s51
  s_cmp_ge_u32 s50, 14
  s_cselect_b32 s51, 14, 0
  s_sub_u32 s50, s50, s51
  s_cmp_ge_u32 s50, 7
  s_cselect_b32 s51, 7, 0
  s_sub_u32 s50, s50, s51
  s_cmp_ge_u32 s50, 7
  s_cselect_b32 s51, 7, 0
  s_sub_u32 s50, s50, s51
  v_lshrrev_b32 v3, 3, v0
  v_and_b32 v4, 7, v0
  v_lshrrev_b32 v5, 4, v0
  v_mul_u32_u24 v6, 896, v3
  v_xor_b32 v7, v4, v5
  v_lshl_add_u32 v176, v7, 4, v6
  v_xor_b32 v7, 4, v7
  v_lshl_add_u32 v177, v7, 4, v6
  v_mul_u32_u24 v6, 2688, v3
  v_lshl_add_u32 v253, v4, 4, v6
  v_lshrrev_b32 v3, 2, v0
  v_and_b32 v4, 3, v0
  v_mul_u32_u24 v6, 2688, v3
  v_lshl_add_u32 v178, v4, 4, v6
  v_add_u32 v170, 896, v178
  v_add_u32 v171, 1792, v178
  v_add_u32 v168, 14336, v176
  v_add_u32 v177, 7168, v177
  v_add_u32 v169, 14336, v177
  s_lshl_b32 s66, s39, 2
  s_add_u32 s66, s66, s3
  s_mul_i32 s67, s66, 28672
  s_mul_i32 s68, s38, 56
  s_and_b32 s68, s68, 0xfffffff0
  s_mul_i32 s69, s3, 43008
  s_add_u32 s68, s68, s69
  s_lshl_b32 s69, s50, 7
  s_add_u32 s52, s67, s69
  s_mul_i32 s69, s50, 172032
  s_add_u32 s59, s68, s69
  s_add_u32 s50, s50, 1
  s_cmp_eq_u32 s50, 7
  s_cselect_b32 s50, 0, s50
  s_lshl_b32 s69, s50, 7
  s_add_u32 s53, s67, s69
  s_mul_i32 s69, s50, 172032
  s_add_u32 s60, s68, s69
  s_add_u32 s50, s50, 1
  s_cmp_eq_u32 s50, 7
  s_cselect_b32 s50, 0, s50
  s_lshl_b32 s69, s50, 7
  s_add_u32 s54, s67, s69
  s_mul_i32 s69, s50, 172032
  s_add_u32 s61, s68, s69
  s_add_u32 s50, s50, 1
  s_cmp_eq_u32 s50, 7
  s_cselect_b32 s50, 0, s50
  s_lshl_b32 s69, s50, 7
  s_add_u32 s55, s67, s69
  s_mul_i32 s69, s50, 172032
  s_add_u32 s62, s68, s69
  s_add_u32 s50, s50, 1
  s_cmp_eq_u32 s50, 7
  s_cselect_b32 s50, 0, s50
  s_lshl_b32 s69, s50, 7
  s_add_u32 s56, s67, s69
  s_mul_i32 s69, s50, 172032
  s_add_u32 s63, s68, s69
  s_add_u32 s50, s50, 1
  s_cmp_eq_u32 s50, 7
  s_cselect_b32 s50, 0, s50
  s_lshl_b32 s69, s50, 7
  s_add_u32 s57, s67, s69
  s_mul_i32 s69, s50, 172032
  s_add_u32 s64, s68, s69
  s_add_u32 s50, s50, 1
  s_cmp_eq_u32 s50, 7
  s_cselect_b32 s50, 0, s50
  s_lshl_b32 s69, s50, 7
  s_add_u32 s58, s67, s69
  s_mul_i32 s69, s50, 172032
  s_add_u32 s65, s68, s69
  s_lshl_b32 s70, s3, 14
  s_lshl_b32 s71, s3, 10
  s_add_u32 s71, s71, 65536
  s_mov_b32 s30, 0x1c0000
  s_mov_b32 s31, 0x00020000
  s_mov_b32 s34, 0x126000
  s_mov_b32 s35, 0x00020000
  s_waitcnt lgkmcnt(0)
  s_mov_b32 s28, s4
  s_mov_b32 s29, s5
  s_mov_b32 s32, s6
  s_mov_b32 s33, s7
  s_add_u32 m0, s71, 0
  s_nop 0
  buffer_load_dwordx4 v170, s[32:35], s59 offen lds
  s_add_u32 m0, s71, 28672
  s_nop 0
  buffer_load_dwordx4 v171, s[32:35], s59 offen lds
  s_add_u32 m0, s70, 0
  s_nop 0
  buffer_load_dwordx4 v176, s[28:31], s52 offen lds
  s_add_u32 m0, s70, 1024
  s_nop 0
  buffer_load_dwordx4 v177, s[28:31], s52 offen lds
  s_add_u32 m0, s70, 2048
  s_nop 0
  buffer_load_dwordx4 v168, s[28:31], s52 offen lds
  s_add_u32 m0, s70, 3072
  s_nop 0
  buffer_load_dwordx4 v169, s[28:31], s52 offen lds
  s_getpc_b64 s[24:25]
L_pc:
  s_mov_b32 s26, L_code_end-L_pc
  s_mov_b32 s27, 0x00020000
  s_lshl_b32 s72, s37, 2
  s_add_u32 s72, s72, s3
  s_mul_i32 s72, s72, 384
  v_lshlrev_b32 v3, 7, v0
  s_mov_b64 exec, 7
  buffer_load_dword a16, v3, s[24:27], s72 offen
  s_mov_b64 exec, -1
  s_mul_i32 s49, s36, 28
  s_add_u32 s49, s49, s37
  s_lshl_b32 s67, s49, 2
  s_add_u32 s67, s67, s3
  s_mov_b32 s27, 0x00020000
  s_mov_b32 s75, 896
  s_cmp_lt_u32 s67, 112
  s_cbranch_scc1 L_r_wo
  s_cmp_lt_u32 s67, 504
  s_cbranch_scc1 L_r_w1
  s_sub_u32 s67, s67, 504
  s_mov_b32 s24, s14
  s_mov_b32 s25, s15
  s_mov_b32 s26, 1605632
  s_mul_i32 s50, s67, 1171
  s_lshr_b32 s50, s50, 16
  s_mul_i32 s51, s50, 56
  s_sub_u32 s51, s67, s51
  s_mul_i32 s74, s51, 28672
  s_lshl_b32 s73, s50, 3
  s_sub_u32 s51, s51, s73
  s_cselect_b32 s73, 56, 0
  s_add_u32 s51, s51, s73
  s_mov_b32 s68, 114688
  s_mov_b32 s69, 2064384
  s_branch L_r_set
L_r_wo:
  s_mov_b32 s24, s8
  s_mov_b32 s25, s9
  s_mov_b32 s26, 401408
  s_lshr_b32 s50, s67, 4
  s_and_b32 s51, s67, 15
  s_mul_i32 s74, s51, 25088
  s_sub_u32 s73, s51, s50
  s_and_b32 s73, s73, 3
  s_and_b32 s51, s51, 12
  s_or_b32 s51, s51, s73
  s_mov_b32 s68, 32768
  s_mov_b32 s69, 0
  s_branch L_r_set
L_r_w1:
  s_sub_u32 s67, s67, 112
  s_mov_b32 s24, s12
  s_mov_b32 s25, s13
  s_mov_b32 s26, 1605632
  s_mul_i32 s50, s67, 4682
  s_lshr_b32 s50, s50, 16
  s_mul_i32 s51, s50, 14
  s_sub_u32 s51, s67, s51
  s_mul_i32 s74, s51, 114688
  s_lshr_b32 s73, s50, 1
  s_sub_u32 s51, s51, s73
  s_cselect_b32 s73, 14, 0
  s_add_u32 s51, s51, s73
  s_mov_b32 s75, 3584
  s_mov_b32 s68, 28672
  s_mov_b32 s69, 458752
L_r_set:
  s_lshl_b32 s73, s50, 7
  s_add_u32 s8, s74, s73
  s_lshl_b32 s73, s75, 3
  s_add_u32 s9, s8, s73
  s_add_u32 s10, s9, s73
  s_add_u32 s11, s10, s73
  s_lshl_b32 s50, s50, 1
  s_mul_i32 s50, s50, s68
  s_lshl_b32 s51, s51, 11
  s_add_u32 s50, s50, s51
  s_add_u32 s22, s50, s69
  s_add_u32 s23, s22, s68
  s_cmp_lt_u32 s37, 28
  s_cselect_b32 s26, s26, 0
  s_cselect_b32 s22, s22, 0x40000000
  s_cselect_b32 s23, s23, 0x40000000
  v_lshrrev_b32 v3, 3, v0
  v_and_b32 v4, 7, v0
  v_mul_lo_u32 v3, v3, s75
  v_lshl_add_u32 v247, v4, 4, v3
  s_mov_b32 s42, 0
  s_mov_b32 s43, -1
  s_mul_i32 s50, s37, 37
  s_lshr_b32 s50, s50, 8
  s_mul_i32 s51, s50, 7
  s_sub_u32 s44, s37, s51
  s_lshl_b32 s45, s36, 2
  s_add_u32 s45, s45, s50
  s_cmp_ge_u32 s37, 14
  s_cselect_b32 s50, 1, 0
  s_cselect_b32 s48, 14, 0
  s_sub_u32 s46, s37, s48
  s_lshl_b32 s47, s36, 1
  s_add_u32 s47, s47, s50
  s_lshr_b32 s12, s3, 1
  s_lshl_b32 s50, s44, 1
  s_add_u32 s12, s12, s50
  s_and_b32 s13, s3, 1
  s_lshl_b32 s50, s45, 1
  s_add_u32 s13, s13, s50
  s_or_b32 s50, s2, s3
  s_cmp_lg_u32 s50, 0
  s_cbranch_scc1 L_nonce_done
  s_or_b32 s40, s40, 1
  v_mov_b32 v4, s40
  v_mov_b32 v5, s41
  s_mov_b64 exec, 1
  global_store_dwordx2 v1, v[4:5], s[18:19] sc1
  s_mov_b64 exec, -1
L_nonce_done:
  v_and_b32 v3, 31, v0
  v_lshrrev_b32 v4, 5, v0
  v_bfe_u32 v5, v0, 1, 3
  v_xor_b32 v5, v5, v4
  v_lshlrev_b32 v7, 7, v3
  v_add_u32 v7, s70, v7
  s_add_u32 s72, s3, 0
  s_and_b32 s72, s72, 3
  s_lshl_b32 s72, s72, 1
  v_xor_b32 v6, s72, v5
  v_lshl_add_u32 v179, v6, 4, v7
  s_add_u32 s72, s3, 1
  s_and_b32 s72, s72, 3
  s_lshl_b32 s72, s72, 1
  v_xor_b32 v6, s72, v5
  v_lshl_add_u32 v180, v6, 4, v7
  s_add_u32 s72, s3, 2
  s_and_b32 s72, s72, 3
  s_lshl_b32 s72, s72, 1
  v_xor_b32 v6, s72, v5
  v_lshl_add_u32 v181, v6, 4, v7
  s_add_u32 s72, s3, 3
  s_and_b32 s72, s72, 3
  s_lshl_b32 s72, s72, 1
  v_xor_b32 v6, s72, v5
  v_lshl_add_u32 v182, v6, 4, v7
  v_lshlrev_b32 v3, 4, v3
  v_add_u32 v254, 151552, v3
  s_lshl_b32 s73, s3, 2
  v_add_u32 v183, s73, v254
  v_bfe_u32 v3, v0, 2, 2
  v_lshl_add_u32 v3, v4, 3, v3
  v_lshlrev_b32 v3, 6, v3
  v_bfe_u32 v5, v0, 4, 1
  v_lshl_add_u32 v3, v5, 5, v3
  v_and_b32 v5, 3, v0
  v_lshl_add_u32 v3, v5, 3, v3
  s_and_b32 s73, s38, 1
  s_lshl_b32 s73, s73, 3
  s_add_u32 s73, s73, 65536
  v_add_u32 v6, s73, v3
  s_lshl_b32 s73, s3, 10
  v_add_u32 v172, s73, v6
  s_add_u32 s73, s73, 1024
  s_and_b32 s73, s73, 0xfff
  v_add_u32 v173, s73, v6
  s_add_u32 s73, s73, 1024
  s_and_b32 s73, s73, 0xfff
  v_add_u32 v174, s73, v6
  s_add_u32 s73, s73, 1024
  s_and_b32 s73, s73, 0xfff
  v_add_u32 v175, s73, v6
  v_add_u32 v7, s70, v2
  v_mov_b32 v240, 0
  v_mov_b32 v241, 0
  v_mov_b32 v242, 0
  v_mov_b32 v243, 0
  v_mov_b32 v245, 0x3f803f80
  v_sub_u32 v3, 0, v4
  v_mov_b32 v255, 0
  v_mov_b32 v4, 0
  s_mov_b32 s74, 0x10000000
  s_mov_b32 s75, 0x10000000
  s_mov_b64 exec, s[74:75]
  v_mov_b32 v255, -1
  s_mov_b32 s74, 0xf0000000
  s_mov_b32 s75, 0xf0000000
  s_mov_b64 exec, s[74:75]
  v_mov_b32 v4, -1
  s_mov_b64 exec, -1
  v_and_b32 v5, v255, v245
  s_lshl_b32 s67, s38, 6
  s_add_u32 s67, s67, s66
  s_lshl_b32 s4, s67, 12
  s_add_u32 s4, s4, 4194304
  s_lshl_b32 s6, s38, 4
  s_add_u32 s6, s6, s39
  s_lshl_b32 s6, s6, 7
  s_add_u32 s6, s6, 3932160
  s_mov_b32 s5, s70
  s_lshl_b32 s73, s49, 3
  s_add_u32 s73, s73, 4096000
  s_cmp_lt_u32 s37, 28
  s_cselect_b32 s7, s73, 0x40000000
  s_add_u32 m0, s71, 4096
  s_nop 0
  buffer_load_dwordx4 v170, s[32:35], s60 offen lds
  s_add_u32 m0, s71, 32768
  s_nop 0
  buffer_load_dwordx4 v171, s[32:35], s60 offen lds
  s_add_u32 m0, s70, 4096
  s_nop 0
  buffer_load_dwordx4 v176, s[28:31], s53 offen lds
  s_add_u32 m0, s70, 5120
  s_nop 0
  buffer_load_dwordx4 v177, s[28:31], s53 offen lds
  s_add_u32 m0, s70, 6144
  s_nop 0
  buffer_load_dwordx4 v168, s[28:31], s53 offen lds
  s_add_u32 m0, s70, 7168
  s_nop 0
  buffer_load_dwordx4 v169, s[28:31], s53 offen lds
  s_add_u32 m0, s71, 8192
  s_nop 0
  buffer_load_dwordx4 v170, s[32:35], s61 offen lds
  s_add_u32 m0, s71, 36864
  s_nop 0
  buffer_load_dwordx4 v171, s[32:35], s61 offen lds
  s_add_u32 m0, s70, 8192
  s_nop 0
  buffer_load_dwordx4 v176, s[28:31], s54 offen lds
  s_add_u32 m0, s70, 9216
  s_nop 0
  buffer_load_dwordx4 v177, s[28:31], s54 offen lds
  s_add_u32 m0, s70, 10240
  s_nop 0
  buffer_load_dwordx4 v168, s[28:31], s54 offen lds
  s_add_u32 m0, s70, 11264
  s_nop 0
  buffer_load_dwordx4 v169, s[28:31], s54 offen lds
  s_waitcnt vmcnt(13)
  s_barrier
  ds_read_b128 v[8:11], v179 offset:0
  ds_read_b128 v[12:15], v180 offset:0
  ds_read_b128 v[16:19], v181 offset:0
  ds_read_b128 v[20:23], v182 offset:0
  ds_read_b64_tr_b16 v[216:217], v172 offset:0
  ds_read_b64_tr_b16 v[218:219], v172 offset:256
  ds_read_b64_tr_b16 v[220:221], v172 offset:28672
  ds_read_b64_tr_b16 v[222:223], v172 offset:28928
  ds_read_b64_tr_b16 v[224:225], v173 offset:0
  ds_read_b64_tr_b16 v[226:227], v173 offset:256
  ds_read_b64_tr_b16 v[228:229], v173 offset:28672
  ds_read_b64_tr_b16 v[230:231], v173 offset:28928
  s_waitcnt lgkmcnt(4)
  v_bfi_b32 v216, v255, v245, v216
  v_bfi_b32 v217, v255, v245, v217
  v_bfi_b32 v218, v255, v245, v218
  v_bfi_b32 v219, v255, v245, v219
  v_mfma_f32_32x32x16_bf16 v[200:215], v[8:11], v[220:223], 0
  ds_read_b64_tr_b16 v[232:233], v174 offset:0
  ds_read_b64_tr_b16 v[234:235], v174 offset:256
  ds_read_b64_tr_b16 v[236:237], v174 offset:28672
  ds_read_b64_tr_b16 v[238:239], v174 offset:28928
  s_add_u32 m0, s71, 12288
  v_mfma_f32_32x32x16_bf16 v[184:199], v[216:219], v[8:11], 0
  buffer_load_dwordx4 v170, s[32:35], s62 offen lds
  s_add_u32 m0, s71, 40960
  s_waitcnt lgkmcnt(4)
  v_bfi_b32 v224, v255, v245, v224
  v_bfi_b32 v225, v255, v245, v225
  v_bfi_b32 v226, v255, v245, v226
  v_bfi_b32 v227, v255, v245, v227
  buffer_load_dwordx4 v171, s[32:35], s62 offen lds
  v_dot2c_f32_bf16 v242, v216, v245
  v_dot2c_f32_bf16 v243, v220, v245
  v_dot2c_f32_bf16 v242, v217, v245
  v_dot2c_f32_bf16 v243, v221, v245
  v_dot2c_f32_bf16 v242, v218, v245
  v_dot2c_f32_bf16 v243, v222, v245
  v_dot2c_f32_bf16 v242, v219, v245
  v_dot2c_f32_bf16 v243, v223, v245
  v_mfma_f32_32x32x16_bf16 v[200:215], v[12:15], v[228:231], v[200:215]
  ds_read_b64_tr_b16 v[216:217], v175 offset:0
  ds_read_b64_tr_b16 v[218:219], v175 offset:256
  ds_read_b64_tr_b16 v[220:221], v175 offset:28672
  ds_read_b64_tr_b16 v[222:223], v175 offset:28928
  s_add_u32 m0, s70, 12288
  v_mfma_f32_32x32x16_bf16 v[184:199], v[224:227], v[12:15], v[184:199]
  buffer_load_dwordx4 v176, s[28:31], s55 offen lds
  s_add_u32 m0, s70, 13312
  s_waitcnt lgkmcnt(4)
  v_bfi_b32 v232, v255, v245, v232
  v_bfi_b32 v233, v255, v245, v233
  v_bfi_b32 v234, v255, v245, v234
  v_bfi_b32 v235, v255, v245, v235
  buffer_load_dwordx4 v177, s[28:31], s55 offen lds
  v_mfma_f32_32x32x16_bf16 v[200:215], v[16:19], v[236:239], v[200:215]
  s_waitcnt vmcnt(10)
  s_barrier
  ds_read_b128 v[24:27], v179 offset:4096
  ds_read_b128 v[28:31], v180 offset:4096
  ds_read_b128 v[32:35], v181 offset:4096
  ds_read_b128 v[36:39], v182 offset:4096
  ds_read_b64_tr_b16 v[224:225], v172 offset:4096
  ds_read_b64_tr_b16 v[226:227], v172 offset:4352
  ds_read_b64_tr_b16 v[228:229], v172 offset:32768
  ds_read_b64_tr_b16 v[230:231], v172 offset:33024
  s_add_u32 m0, s70, 14336
  v_mfma_f32_32x32x16_bf16 v[184:199], v[232:235], v[16:19], v[184:199]
  buffer_load_dwordx4 v168, s[28:31], s55 offen lds
  s_add_u32 m0, s70, 15360
  s_waitcnt lgkmcnt(8)
  v_bfi_b32 v216, v255, v245, v216
  v_bfi_b32 v217, v255, v245, v217
  v_bfi_b32 v218, v255, v245, v218
  v_bfi_b32 v219, v255, v245, v219
  buffer_load_dwordx4 v169, s[28:31], s55 offen lds
  v_mfma_f32_32x32x16_bf16 v[200:215], v[20:23], v[220:223], v[200:215]
  ds_read_b64_tr_b16 v[232:233], v173 offset:4096
  ds_read_b64_tr_b16 v[234:235], v173 offset:4352
  ds_read_b64_tr_b16 v[236:237], v173 offset:32768
  ds_read_b64_tr_b16 v[238:239], v173 offset:33024
  s_add_u32 m0, s71, 16384
  v_mfma_f32_32x32x16_bf16 v[184:199], v[216:219], v[20:23], v[184:199]
  buffer_load_dwordx4 v170, s[32:35], s63 offen lds
  s_add_u32 m0, s71, 45056
  s_waitcnt lgkmcnt(4)
  v_bfi_b32 v224, v255, v245, v224
  v_bfi_b32 v225, v255, v245, v225
  v_bfi_b32 v226, v255, v245, v226
  v_bfi_b32 v227, v255, v245, v227
  buffer_load_dwordx4 v171, s[32:35], s63 offen lds
  v_mfma_f32_32x32x16_bf16 v[200:215], v[24:27], v[228:231], v[200:215]
  ds_read_b64_tr_b16 v[216:217], v174 offset:4096
  ds_read_b64_tr_b16 v[218:219], v174 offset:4352
  ds_read_b64_tr_b16 v[220:221], v174 offset:32768
  ds_read_b64_tr_b16 v[222:223], v174 offset:33024
  v_mfma_f32_32x32x16_bf16 v[184:199], v[224:227], v[24:27], v[184:199]
  buffer_load_dwordx4 v[120:123], v176, s[28:31], s56 offen
  s_waitcnt lgkmcnt(4)
  v_bfi_b32 v232, v255, v245, v232
  v_bfi_b32 v233, v255, v245, v233
  v_bfi_b32 v234, v255, v245, v234
  v_bfi_b32 v235, v255, v245, v235
  buffer_load_dwordx4 v[124:127], v177, s[28:31], s56 offen
  v_dot2c_f32_bf16 v242, v224, v245
  v_dot2c_f32_bf16 v243, v228, v245
  v_dot2c_f32_bf16 v242, v225, v245
  v_dot2c_f32_bf16 v243, v229, v245
  v_dot2c_f32_bf16 v242, v226, v245
  v_dot2c_f32_bf16 v243, v230, v245
  v_dot2c_f32_bf16 v242, v227, v245
  v_dot2c_f32_bf16 v243, v231, v245
  v_dot2c_f32_bf16 v241, v8, v8
  v_dot2c_f32_bf16 v240, v9, v9
  v_dot2c_f32_bf16 v241, v10, v10
  v_dot2c_f32_bf16 v240, v11, v11
  v_dot2c_f32_bf16 v241, v12, v12
  v_dot2c_f32_bf16 v240, v13, v13
  v_dot2c_f32_bf16 v241, v14, v14
  v_dot2c_f32_bf16 v240, v15, v15
  v_dot2c_f32_bf16 v241, v16, v16
  v_dot2c_f32_bf16 v240, v17, v17
  v_dot2c_f32_bf16 v241, v18, v18
  v_dot2c_f32_bf16 v240, v19, v19
  v_dot2c_f32_bf16 v241, v20, v20
  v_dot2c_f32_bf16 v240, v21, v21
  v_dot2c_f32_bf16 v241, v22, v22
  v_dot2c_f32_bf16 v240, v23, v23
  v_dot2c_f32_bf16 v241, v24, v24
  v_dot2c_f32_bf16 v240, v25, v25
  v_dot2c_f32_bf16 v241, v26, v26
  v_dot2c_f32_bf16 v240, v27, v27
  v_mfma_f32_32x32x16_bf16 v[200:215], v[28:31], v[236:239], v[200:215]
  ds_read_b64_tr_b16 v[224:225], v175 offset:4096
  ds_read_b64_tr_b16 v[226:227], v175 offset:4352
  ds_read_b64_tr_b16 v[228:229], v175 offset:32768
  ds_read_b64_tr_b16 v[230:231], v175 offset:33024
  v_mfma_f32_32x32x16_bf16 v[184:199], v[232:235], v[28:31], v[184:199]
  buffer_load_dwordx4 v[128:131], v168, s[28:31], s56 offen
  s_waitcnt lgkmcnt(4)
  v_bfi_b32 v216, v255, v245, v216
  v_bfi_b32 v217, v255, v245, v217
  v_bfi_b32 v218, v255, v245, v218
  v_bfi_b32 v219, v255, v245, v219
  buffer_load_dwordx4 v[132:135], v169, s[28:31], s56 offen
  v_mfma_f32_32x32x16_bf16 v[200:215], v[32:35], v[220:223], v[200:215]
  s_waitcnt vmcnt(12)
  s_barrier
  ds_read_b128 v[40:43], v179 offset:8192
  ds_read_b128 v[44:47], v180 offset:8192
  ds_read_b128 v[48:51], v181 offset:8192
  ds_read_b128 v[52:55], v182 offset:8192
  ds_read_b64_tr_b16 v[232:233], v172 offset:8192
  ds_read_b64_tr_b16 v[234:235], v172 offset:8448
  ds_read_b64_tr_b16 v[236:237], v172 offset:36864
  ds_read_b64_tr_b16 v[238:239], v172 offset:37120
  s_add_u32 m0, s71, 20480
  v_mfma_f32_32x32x16_bf16 v[184:199], v[216:219], v[32:35], v[184:199]
  buffer_load_dwordx4 v170, s[32:35], s64 offen lds
  s_add_u32 m0, s71, 49152
  s_waitcnt lgkmcnt(8)
  v_bfi_b32 v224, v255, v245, v224
  v_bfi_b32 v225, v255, v245, v225
  v_bfi_b32 v226, v255, v245, v226
  v_bfi_b32 v227, v255, v245, v227
  buffer_load_dwordx4 v171, s[32:35], s64 offen lds
  v_mfma_f32_32x32x16_bf16 v[200:215], v[36:39], v[228:231], v[200:215]
  ds_read_b64_tr_b16 v[216:217], v173 offset:8192
  ds_read_b64_tr_b16 v[218:219], v173 offset:8448
  ds_read_b64_tr_b16 v[220:221], v173 offset:36864
  ds_read_b64_tr_b16 v[222:223], v173 offset:37120
  v_mfma_f32_32x32x16_bf16 v[184:199], v[224:227], v[36:39], v[184:199]
  buffer_load_dwordx4 v[136:139], v176, s[28:31], s57 offen
  s_waitcnt lgkmcnt(4)
  v_bfi_b32 v232, v255, v245, v232
  v_bfi_b32 v233, v255, v245, v233
  v_bfi_b32 v234, v255, v245, v234
  v_bfi_b32 v235, v255, v245, v235
  buffer_load_dwordx4 v[140:143], v177, s[28:31], s57 offen
  v_mfma_f32_32x32x16_bf16 v[200:215], v[40:43], v[236:239], v[200:215]
  ds_read_b64_tr_b16 v[224:225], v174 offset:8192
  ds_read_b64_tr_b16 v[226:227], v174 offset:8448
  ds_read_b64_tr_b16 v[228:229], v174 offset:36864
  ds_read_b64_tr_b16 v[230:231], v174 offset:37120
  v_mfma_f32_32x32x16_bf16 v[184:199], v[232:235], v[40:43], v[184:199]
  buffer_load_dwordx4 v[144:147], v168, s[28:31], s57 offen
  s_waitcnt lgkmcnt(4)
  v_bfi_b32 v216, v255, v245, v216
  v_bfi_b32 v217, v255, v245, v217
  v_bfi_b32 v218, v255, v245, v218
  v_bfi_b32 v219, v255, v245, v219
  buffer_load_dwordx4 v[148:151], v169, s[28:31], s57 offen
  v_dot2c_f32_bf16 v242, v232, v245
  v_dot2c_f32_bf16 v243, v236, v245
  v_dot2c_f32_bf16 v242, v233, v245
  v_dot2c_f32_bf16 v243, v237, v245
  v_dot2c_f32_bf16 v242, v234, v245
  v_dot2c_f32_bf16 v243, v238, v245
  v_dot2c_f32_bf16 v242, v235, v245
  v_dot2c_f32_bf16 v243, v239, v245
  v_dot2c_f32_bf16 v241, v28, v28
  v_dot2c_f32_bf16 v240, v29, v29
  v_dot2c_f32_bf16 v241, v30, v30
  v_dot2c_f32_bf16 v240, v31, v31
  v_dot2c_f32_bf16 v241, v32, v32
  v_dot2c_f32_bf16 v240, v33, v33
  v_dot2c_f32_bf16 v241, v34, v34
  v_dot2c_f32_bf16 v240, v35, v35
  v_dot2c_f32_bf16 v241, v36, v36
  v_dot2c_f32_bf16 v240, v37, v37
  v_dot2c_f32_bf16 v241, v38, v38
  v_dot2c_f32_bf16 v240, v39, v39
  v_dot2c_f32_bf16 v241, v40, v40
  v_dot2c_f32_bf16 v240, v41, v41
  v_dot2c_f32_bf16 v241, v42, v42
  v_dot2c_f32_bf16 v240, v43, v43
  v_mfma_f32_32x32x16_bf16 v[200:215], v[44:47], v[220:223], v[200:215]
  ds_read_b64_tr_b16 v[232:233], v175 offset:8192
  ds_read_b64_tr_b16 v[234:235], v175 offset:8448
  ds_read_b64_tr_b16 v[236:237], v175 offset:36864
  ds_read_b64_tr_b16 v[238:239], v175 offset:37120
  v_mfma_f32_32x32x16_bf16 v[184:199], v[216:219], v[44:47], v[184:199]
  s_waitcnt lgkmcnt(4)
  v_bfi_b32 v224, v255, v245, v224
  v_bfi_b32 v225, v255, v245, v225
  v_bfi_b32 v226, v255, v245, v226
  v_bfi_b32 v227, v255, v245, v227
  v_mfma_f32_32x32x16_bf16 v[200:215], v[48:51], v[228:231], v[200:215]
  s_waitcnt vmcnt(12)
  s_barrier
  ds_read_b128 v[56:59], v179 offset:12288
  ds_read_b128 v[60:63], v180 offset:12288
  ds_read_b128 v[64:67], v181 offset:12288
  ds_read_b128 v[68:71], v182 offset:12288
  ds_read_b64_tr_b16 v[216:217], v172 offset:12288
  ds_read_b64_tr_b16 v[218:219], v172 offset:12544
  ds_read_b64_tr_b16 v[220:221], v172 offset:40960
  ds_read_b64_tr_b16 v[222:223], v172 offset:41216
  s_add_u32 m0, s71, 24576
  v_mfma_f32_32x32x16_bf16 v[184:199], v[224:227], v[48:51], v[184:199]
  buffer_load_dwordx4 v170, s[32:35], s65 offen lds
  s_add_u32 m0, s71, 53248
  s_waitcnt lgkmcnt(8)
  v_bfi_b32 v232, v255, v245, v232
  v_bfi_b32 v233, v255, v245, v233
  v_bfi_b32 v234, v255, v245, v234
  v_bfi_b32 v235, v255, v245, v235
  buffer_load_dwordx4 v171, s[32:35], s65 offen lds
  v_mfma_f32_32x32x16_bf16 v[200:215], v[52:55], v[236:239], v[200:215]
  ds_read_b64_tr_b16 v[224:225], v173 offset:12288
  ds_read_b64_tr_b16 v[226:227], v173 offset:12544
  ds_read_b64_tr_b16 v[228:229], v173 offset:40960
  ds_read_b64_tr_b16 v[230:231], v173 offset:41216
  v_mfma_f32_32x32x16_bf16 v[184:199], v[232:235], v[52:55], v[184:199]
  buffer_load_dwordx4 v[152:155], v176, s[28:31], s58 offen
  s_waitcnt lgkmcnt(4)
  v_bfi_b32 v216, v255, v245, v216
  v_bfi_b32 v217, v255, v245, v217
  v_bfi_b32 v218, v255, v245, v218
  v_bfi_b32 v219, v255, v245, v219
  buffer_load_dwordx4 v[156:159], v177, s[28:31], s58 offen
  v_mfma_f32_32x32x16_bf16 v[200:215], v[56:59], v[220:223], v[200:215]
  ds_read_b64_tr_b16 v[232:233], v174 offset:12288
  ds_read_b64_tr_b16 v[234:235], v174 offset:12544
  ds_read_b64_tr_b16 v[236:237], v174 offset:40960
  ds_read_b64_tr_b16 v[238:239], v174 offset:41216
  v_mfma_f32_32x32x16_bf16 v[184:199], v[216:219], v[56:59], v[184:199]
  buffer_load_dwordx4 v[160:163], v168, s[28:31], s58 offen
  s_waitcnt lgkmcnt(4)
  v_bfi_b32 v224, v255, v245, v224
  v_bfi_b32 v225, v255, v245, v225
  v_bfi_b32 v226, v255, v245, v226
  v_bfi_b32 v227, v255, v245, v227
  buffer_load_dwordx4 v[164:167], v169, s[28:31], s58 offen
  v_dot2c_f32_bf16 v242, v216, v245
  v_dot2c_f32_bf16 v243, v220, v245
  v_dot2c_f32_bf16 v242, v217, v245
  v_dot2c_f32_bf16 v243, v221, v245
  v_dot2c_f32_bf16 v242, v218, v245
  v_dot2c_f32_bf16 v243, v222, v245
  v_dot2c_f32_bf16 v242, v219, v245
  v_dot2c_f32_bf16 v243, v223, v245
  v_dot2c_f32_bf16 v241, v44, v44
  v_dot2c_f32_bf16 v240, v45, v45
  v_dot2c_f32_bf16 v241, v46, v46
  v_dot2c_f32_bf16 v240, v47, v47
  v_dot2c_f32_bf16 v241, v48, v48
  v_dot2c_f32_bf16 v240, v49, v49
  v_dot2c_f32_bf16 v241, v50, v50
  v_dot2c_f32_bf16 v240, v51, v51
  v_dot2c_f32_bf16 v241, v52, v52
  v_dot2c_f32_bf16 v240, v53, v53
  v_dot2c_f32_bf16 v241, v54, v54
  v_dot2c_f32_bf16 v240, v55, v55
  v_dot2c_f32_bf16 v241, v56, v56
  v_dot2c_f32_bf16 v240, v57, v57
  v_dot2c_f32_bf16 v241, v58, v58
  v_dot2c_f32_bf16 v240, v59, v59
  v_mfma_f32_32x32x16_bf16 v[200:215], v[60:63], v[228:231], v[200:215]
  ds_read_b64_tr_b16 v[216:217], v175 offset:12288
  ds_read_b64_tr_b16 v[218:219], v175 offset:12544
  ds_read_b64_tr_b16 v[220:221], v175 offset:40960
  ds_read_b64_tr_b16 v[222:223], v175 offset:41216
  v_mfma_f32_32x32x16_bf16 v[184:199], v[224:227], v[60:63], v[184:199]
  s_waitcnt lgkmcnt(4)
  v_bfi_b32 v232, v255, v245, v232
  v_bfi_b32 v233, v255, v245, v233
  v_bfi_b32 v234, v255, v245, v234
  v_bfi_b32 v235, v255, v245, v235
  v_mfma_f32_32x32x16_bf16 v[200:215], v[64:67], v[236:239], v[200:215]
  s_waitcnt vmcnt(12)
  ds_write_b128 v7, v[120:123] offset:0
  ds_write_b128 v7, v[124:127] offset:1024
  ds_write_b128 v7, v[128:131] offset:2048
  ds_write_b128 v7, v[132:135] offset:3072
  s_barrier
  ds_read_b128 v[72:75], v179 offset:0
  ds_read_b128 v[76:79], v180 offset:0
  ds_read_b128 v[80:83], v181 offset:0
  ds_read_b128 v[84:87], v182 offset:0
  ds_read_b64_tr_b16 v[224:225], v172 offset:16384
  ds_read_b64_tr_b16 v[226:227], v172 offset:16640
  ds_read_b64_tr_b16 v[228:229], v172 offset:45056
  s_waitcnt lgkmcnt(12)
  ds_read_b64_tr_b16 v[230:231], v172 offset:45312
  s_add_u32 m0, s71, 57344
  v_mfma_f32_32x32x16_bf16 v[184:199], v[232:235], v[64:67], v[184:199]
  buffer_load_dwordx4 v178, s[32:35], s59 offen lds
  s_add_u32 m0, s71, 61440
  s_waitcnt lgkmcnt(12)
  v_bfi_b32 v216, v255, v245, v216
  v_bfi_b32 v217, v255, v245, v217
  v_bfi_b32 v218, v255, v245, v218
  v_bfi_b32 v219, v255, v245, v219
  buffer_load_dwordx4 v178, s[32:35], s60 offen lds
  v_mfma_f32_32x32x16_bf16 v[200:215], v[68:71], v[220:223], v[200:215]
  ds_read_b64_tr_b16 v[232:233], v173 offset:16384
  ds_read_b64_tr_b16 v[234:235], v173 offset:16640
  ds_read_b64_tr_b16 v[236:237], v173 offset:45056
  s_waitcnt lgkmcnt(12)
  ds_read_b64_tr_b16 v[238:239], v173 offset:45312
  s_add_u32 m0, s71, 65536
  v_mfma_f32_32x32x16_bf16 v[184:199], v[216:219], v[68:71], v[184:199]
  buffer_load_dwordx4 v178, s[32:35], s61 offen lds
  s_add_u32 m0, s71, 69632
  s_waitcnt lgkmcnt(4)
  v_bfi_b32 v224, v255, v245, v224
  v_bfi_b32 v225, v255, v245, v225
  v_bfi_b32 v226, v255, v245, v226
  v_bfi_b32 v227, v255, v245, v227
  buffer_load_dwordx4 v178, s[32:35], s62 offen lds
  v_mfma_f32_32x32x16_bf16 v[200:215], v[72:75], v[228:231], v[200:215]
  ds_read_b64_tr_b16 v[216:217], v174 offset:16384
  ds_read_b64_tr_b16 v[218:219], v174 offset:16640
  ds_read_b64_tr_b16 v[220:221], v174 offset:45056
  ds_read_b64_tr_b16 v[222:223], v174 offset:45312
  s_add_u32 m0, s71, 73728
  v_mfma_f32_32x32x16_bf16 v[184:199], v[224:227], v[72:75], v[184:199]
  buffer_load_dwordx4 v178, s[32:35], s63 offen lds
  s_add_u32 m0, s71, 77824
  s_waitcnt lgkmcnt(4)
  v_bfi_b32 v232, v255, v245, v232
  v_bfi_b32 v233, v255, v245, v233
  v_bfi_b32 v234, v255, v245, v234
  v_bfi_b32 v235, v255, v245, v235
  buffer_load_dwordx4 v178, s[32:35], s64 offen lds
  v_dot2c_f32_bf16 v242, v224, v245
  v_dot2c_f32_bf16 v243, v228, v245
  v_dot2c_f32_bf16 v242, v225, v245
  v_dot2c_f32_bf16 v243, v229, v245
  v_dot2c_f32_bf16 v242, v226, v245
  v_dot2c_f32_bf16 v243, v230, v245
  v_dot2c_f32_bf16 v242, v227, v245
  v_dot2c_f32_bf16 v243, v231, v245
  v_dot2c_f32_bf16 v241, v60, v60
  v_dot2c_f32_bf16 v240, v61, v61
  v_dot2c_f32_bf16 v241, v62, v62
  v_dot2c_f32_bf16 v240, v63, v63
  v_dot2c_f32_bf16 v241, v64, v64
  v_dot2c_f32_bf16 v240, v65, v65
  v_dot2c_f32_bf16 v241, v66, v66
  v_dot2c_f32_bf16 v240, v67, v67
  v_dot2c_f32_bf16 v241, v68, v68
  v_dot2c_f32_bf16 v240, v69, v69
  v_dot2c_f32_bf16 v241, v70, v70
  v_dot2c_f32_bf16 v240, v71, v71
  v_dot2c_f32_bf16 v241, v72, v72
  v_dot2c_f32_bf16 v240, v73, v73
  v_dot2c_f32_bf16 v241, v74, v74
  v_dot2c_f32_bf16 v240, v75, v75
  v_mfma_f32_32x32x16_bf16 v[200:215], v[76:79], v[236:239], v[200:215]
  ds_read_b64_tr_b16 v[224:225], v175 offset:16384
  ds_read_b64_tr_b16 v[226:227], v175 offset:16640
  ds_read_b64_tr_b16 v[228:229], v175 offset:45056
  ds_read_b64_tr_b16 v[230:231], v175 offset:45312
  s_add_u32 m0, s71, 81920
  v_mfma_f32_32x32x16_bf16 v[184:199], v[232:235], v[76:79], v[184:199]
  buffer_load_dwordx4 v178, s[32:35], s65 offen lds
  s_waitcnt lgkmcnt(4)
  v_bfi_b32 v216, v255, v245, v216
  v_bfi_b32 v217, v255, v245, v217
  v_bfi_b32 v218, v255, v245, v218
  v_bfi_b32 v219, v255, v245, v219
  v_mfma_f32_32x32x16_bf16 v[200:215], v[80:83], v[220:223], v[200:215]
  s_waitcnt vmcnt(13)
  ds_write_b128 v7, v[136:139] offset:4096
  ds_write_b128 v7, v[140:143] offset:5120
  ds_write_b128 v7, v[144:147] offset:6144
  ds_write_b128 v7, v[148:151] offset:7168
  s_barrier
  ds_read_b128 v[88:91], v179 offset:4096
  ds_read_b128 v[92:95], v180 offset:4096
  ds_read_b128 v[96:99], v181 offset:4096
  ds_read_b128 v[100:103], v182 offset:4096
  ds_read_b64_tr_b16 v[232:233], v172 offset:20480
  ds_read_b64_tr_b16 v[234:235], v172 offset:20736
  ds_read_b64_tr_b16 v[236:237], v172 offset:49152
  s_waitcnt lgkmcnt(12)
  ds_read_b64_tr_b16 v[238:239], v172 offset:49408
  v_mfma_f32_32x32x16_bf16 v[184:199], v[216:219], v[80:83], v[184:199]
  buffer_load_dwordx4 a[0:3], v247, s[24:27], s8 offen
  s_waitcnt lgkmcnt(12)
  v_bfi_b32 v224, v255, v245, v224
  v_bfi_b32 v225, v255, v245, v225
  v_bfi_b32 v226, v255, v245, v226
  v_bfi_b32 v227, v255, v245, v227
  buffer_load_dwordx4 a[4:7], v247, s[24:27], s9 offen
  v_mfma_f32_32x32x16_bf16 v[200:215], v[84:87], v[228:231], v[200:215]
  ds_read_b64_tr_b16 v[216:217], v173 offset:20480
  ds_read_b64_tr_b16 v[218:219], v173 offset:20736
  ds_read_b64_tr_b16 v[220:221], v173 offset:49152
  s_waitcnt lgkmcnt(12)
  ds_read_b64_tr_b16 v[222:223], v173 offset:49408
  v_mfma_f32_32x32x16_bf16 v[184:199], v[224:227], v[84:87], v[184:199]
  buffer_load_dwordx4 a[8:11], v247, s[24:27], s10 offen
  s_waitcnt lgkmcnt(4)
  v_bfi_b32 v232, v255, v245, v232
  v_bfi_b32 v233, v255, v245, v233
  v_bfi_b32 v234, v255, v245, v234
  v_bfi_b32 v235, v255, v245, v235
  buffer_load_dwordx4 a[12:15], v247, s[24:27], s11 offen
  v_mfma_f32_32x32x16_bf16 v[200:215], v[88:91], v[236:239], v[200:215]
  ds_read_b64_tr_b16 v[224:225], v174 offset:20480
  ds_read_b64_tr_b16 v[226:227], v174 offset:20736
  ds_read_b64_tr_b16 v[228:229], v174 offset:49152
  ds_read_b64_tr_b16 v[230:231], v174 offset:49408
  v_mfma_f32_32x32x16_bf16 v[184:199], v[232:235], v[88:91], v[184:199]
  s_mov_b32 s24, s20
  s_mov_b32 s25, s21
  s_mov_b32 s26, 0x1340000
  s_mov_b32 s27, 0x00020000
  s_mov_b64 exec, 1
  global_load_dwordx2 v[246:247], v1, s[18:19] sc1
  s_mov_b64 exec, -1
  s_waitcnt lgkmcnt(4)
  v_bfi_b32 v216, v255, v245, v216
  v_bfi_b32 v217, v255, v245, v217
  v_bfi_b32 v218, v255, v245, v218
  v_bfi_b32 v219, v255, v245, v219
  v_dot2c_f32_bf16 v242, v232, v245
  v_dot2c_f32_bf16 v243, v236, v245
  v_dot2c_f32_bf16 v242, v233, v245
  v_dot2c_f32_bf16 v243, v237, v245
  v_dot2c_f32_bf16 v242, v234, v245
  v_dot2c_f32_bf16 v243, v238, v245
  v_dot2c_f32_bf16 v242, v235, v245
  v_dot2c_f32_bf16 v243, v239, v245
  v_dot2c_f32_bf16 v241, v76, v76
  v_dot2c_f32_bf16 v240, v77, v77
  v_dot2c_f32_bf16 v241, v78, v78
  v_dot2c_f32_bf16 v240, v79, v79
  v_dot2c_f32_bf16 v241, v80, v80
  v_dot2c_f32_bf16 v240, v81, v81
  v_dot2c_f32_bf16 v241, v82, v82
  v_dot2c_f32_bf16 v240, v83, v83
  v_dot2c_f32_bf16 v241, v84, v84
  v_dot2c_f32_bf16 v240, v85, v85
  v_dot2c_f32_bf16 v241, v86, v86
  v_dot2c_f32_bf16 v240, v87, v87
  v_dot2c_f32_bf16 v241, v88, v88
  v_dot2c_f32_bf16 v240, v89, v89
  v_dot2c_f32_bf16 v241, v90, v90
  v_dot2c_f32_bf16 v240, v91, v91
  v_mfma_f32_32x32x16_bf16 v[200:215], v[92:95], v[220:223], v[200:215]
  ds_read_b64_tr_b16 v[232:233], v175 offset:20480
  ds_read_b64_tr_b16 v[234:235], v175 offset:20736
  ds_read_b64_tr_b16 v[236:237], v175 offset:49152
  ds_read_b64_tr_b16 v[238:239], v175 offset:49408
  v_mfma_f32_32x32x16_bf16 v[184:199], v[216:219], v[92:95], v[184:199]
  s_waitcnt lgkmcnt(4)
  v_bfi_b32 v224, v255, v245, v224
  v_bfi_b32 v225, v255, v245, v225
  v_bfi_b32 v226, v255, v245, v226
  v_bfi_b32 v227, v255, v245, v227
  v_mfma_f32_32x32x16_bf16 v[200:215], v[96:99], v[228:231], v[200:215]
  s_waitcnt vmcnt(12)
  ds_write_b128 v7, v[152:155] offset:8192
  ds_write_b128 v7, v[156:159] offset:9216
  ds_write_b128 v7, v[160:163] offset:10240
  ds_write_b128 v7, v[164:167] offset:11264
  s_barrier
  ds_read_b128 v[104:107], v179 offset:8192
  ds_read_b128 v[108:111], v180 offset:8192
  ds_read_b128 v[112:115], v181 offset:8192
  ds_read_b128 v[116:119], v182 offset:8192
  ds_read_b64_tr_b16 v[216:217], v172 offset:24576
  ds_read_b64_tr_b16 v[218:219], v172 offset:24832
  ds_read_b64_tr_b16 v[220:221], v172 offset:53248
  s_waitcnt lgkmcnt(12)
  ds_read_b64_tr_b16 v[222:223], v172 offset:53504
  v_mfma_f32_32x32x16_bf16 v[184:199], v[224:227], v[96:99], v[184:199]
  s_waitcnt lgkmcnt(12)
  v_bfi_b32 v232, v255, v245, v232
  v_bfi_b32 v233, v255, v245, v233
  v_bfi_b32 v234, v255, v245, v234
  v_bfi_b32 v235, v255, v245, v235
  v_mfma_f32_32x32x16_bf16 v[200:215], v[100:103], v[236:239], v[200:215]
  ds_read_b64_tr_b16 v[224:225], v173 offset:24576
  ds_read_b64_tr_b16 v[226:227], v173 offset:24832
  ds_read_b64_tr_b16 v[228:229], v173 offset:53248
  s_waitcnt lgkmcnt(12)
  ds_read_b64_tr_b16 v[230:231], v173 offset:53504
  v_mfma_f32_32x32x16_bf16 v[184:199], v[232:235], v[100:103], v[184:199]
  s_waitcnt lgkmcnt(4)
  v_bfi_b32 v216, v255, v245, v216
  v_bfi_b32 v217, v255, v245, v217
  v_bfi_b32 v218, v255, v245, v218
  v_bfi_b32 v219, v255, v245, v219
  v_mfma_f32_32x32x16_bf16 v[200:215], v[104:107], v[220:223], v[200:215]
  ds_read_b64_tr_b16 v[232:233], v174 offset:24576
  ds_read_b64_tr_b16 v[234:235], v174 offset:24832
  ds_read_b64_tr_b16 v[236:237], v174 offset:53248
  ds_read_b64_tr_b16 v[238:239], v174 offset:53504
  v_mfma_f32_32x32x16_bf16 v[184:199], v[216:219], v[104:107], v[184:199]
  s_waitcnt lgkmcnt(4)
  v_bfi_b32 v224, v255, v245, v224
  v_bfi_b32 v225, v255, v245, v225
  v_bfi_b32 v226, v255, v245, v226
  v_bfi_b32 v227, v255, v245, v227
  v_dot2c_f32_bf16 v242, v216, v245
  v_dot2c_f32_bf16 v243, v220, v245
  v_dot2c_f32_bf16 v242, v217, v245
  v_dot2c_f32_bf16 v243, v221, v245
  v_dot2c_f32_bf16 v242, v218, v245
  v_dot2c_f32_bf16 v243, v222, v245
  v_dot2c_f32_bf16 v242, v219, v245
  v_dot2c_f32_bf16 v243, v223, v245
  v_dot2c_f32_bf16 v241, v92, v92
  v_dot2c_f32_bf16 v240, v93, v93
  v_dot2c_f32_bf16 v241, v94, v94
  v_dot2c_f32_bf16 v240, v95, v95
  v_dot2c_f32_bf16 v241, v96, v96
  v_dot2c_f32_bf16 v240, v97, v97
  v_dot2c_f32_bf16 v241, v98, v98
  v_dot2c_f32_bf16 v240, v99, v99
  v_dot2c_f32_bf16 v241, v100, v100
  v_dot2c_f32_bf16 v240, v101, v101
  v_dot2c_f32_bf16 v241, v102, v102
  v_dot2c_f32_bf16 v240, v103, v103
  v_dot2c_f32_bf16 v241, v104, v104
  v_dot2c_f32_bf16 v240, v105, v105
  v_dot2c_f32_bf16 v241, v106, v106
  v_dot2c_f32_bf16 v240, v107, v107
  v_mov_b32 v248, v242
  s_nop 1
  v_permlane32_swap_b32 v248, v242
  v_add_f32 v242, v242, v248
  v_mov_b32 v249, v243
  s_nop 1
  v_permlane32_swap_b32 v249, v243
  v_add_f32 v243, v243, v249
  ds_write_b32 v183, v242
  ds_write_b32 v183, v243 offset:512
  v_mfma_f32_32x32x16_bf16 v[200:215], v[108:111], v[228:231], v[200:215]
  ds_read_b64_tr_b16 v[216:217], v175 offset:24576
  ds_read_b64_tr_b16 v[218:219], v175 offset:24832
  ds_read_b64_tr_b16 v[220:221], v175 offset:53248
  ds_read_b64_tr_b16 v[222:223], v175 offset:53504
  v_mfma_f32_32x32x16_bf16 v[184:199], v[224:227], v[108:111], v[184:199]
  s_waitcnt lgkmcnt(6)
  v_bfi_b32 v232, v255, v245, v232
  v_bfi_b32 v233, v255, v245, v233
  v_bfi_b32 v234, v255, v245, v234
  v_bfi_b32 v235, v255, v245, v235
  v_mfma_f32_32x32x16_bf16 v[200:215], v[112:115], v[236:239], v[200:215]
  s_waitcnt lgkmcnt(0)
  s_barrier
  ds_read_b128 v[160:163], v254
  ds_read_b128 v[164:167], v254 offset:512
  v_mfma_f32_32x32x16_bf16 v[184:199], v[232:235], v[112:115], v[184:199]
  v_bfi_b32 v216, v255, v245, v216
  v_bfi_b32 v217, v255, v245, v217
  v_bfi_b32 v218, v255, v245, v218
  v_bfi_b32 v219, v255, v245, v219
  v_mfma_f32_32x32x16_bf16 v[200:215], v[116:119], v[220:223], v[200:215]
  s_nop 0
  v_mfma_f32_32x32x16_bf16 v[184:199], v[216:219], v[116:119], v[184:199]
  v_dot2c_f32_bf16 v241, v108, v108
  v_dot2c_f32_bf16 v240, v109, v109
  v_dot2c_f32_bf16 v241, v110, v110
  v_dot2c_f32_bf16 v240, v111, v111
  v_dot2c_f32_bf16 v241, v112, v112
  v_dot2c_f32_bf16 v240, v113, v113
  v_dot2c_f32_bf16 v241, v114, v114
  v_dot2c_f32_bf16 v240, v115, v115
  v_dot2c_f32_bf16 v241, v116, v116
  v_dot2c_f32_bf16 v240, v117, v117
  v_dot2c_f32_bf16 v241, v118, v118
  v_dot2c_f32_bf16 v240, v119, v119
  s_nop 2
  v_add_f32 v241, v241, v240
  v_mov_b32 v248, v241
  s_nop 1
  v_permlane32_swap_b32 v248, v241
  v_add_f32 v241, v241, v248
  s_waitcnt lgkmcnt(0)
  v_add_f32 v160, v160, v161
  v_add_f32 v162, v162, v163
  v_add_f32 v242, v160, v162
  v_add_f32 v164, v164, v165
  v_add_f32 v166, v166, v167
  v_add_f32 v243, v164, v166
  v_and_b32 v248, 0xffff0000, v242
  v_sub_f32 v249, v242, v248
  v_cvt_pk_bf16_f32 v220, v248, v249
  v_lshrrev_b32 v221, 16, v248
  v_and_b32 v248, 0xffff0000, v243
  v_sub_f32 v249, v243, v248
  v_cvt_pk_bf16_f32 v224, v248, v249
  v_lshrrev_b32 v225, 16, v248
  v_mov_b32 v218, 0
  v_mov_b32 v219, 0
  v_mov_b32 v222, 0
  v_mov_b32 v223, 0
  v_mov_b32 v226, 0
  v_mov_b32 v227, 0
  v_mov_b32 v240, v196
  v_mov_b32 v248, v196
  s_nop 1
  v_permlane32_swap_b32 v248, v240
  v_mul_f32 v240, 0xbb124925, v240
  v_mul_f32 v241, 0x3b124925, v241
  v_fma_f32 v241, -v240, v240, v241
  v_max_f32 v241, 0, v241
  v_add_f32 v248, 0x3727c5ac, v241
  v_rsq_f32 v241, v248
  v_bfi_b32 v240, v3, 0, v240
  v_lshrrev_b32 v250, 2, v2
  v_and_b32 v250, 127, v250
  v_add_u32 v250, s5, v250
  v_and_b32 v248, 0xffff0000, v240
  v_sub_f32 v249, v240, v248
  v_cvt_pk_bf16_f32 v216, v248, v248
  v_cvt_pk_bf16_f32 v217, v249, 0
  ds_write_b32 v250, v241 offset:8192
  s_nop 0
  v_mfma_f32_32x32x16_bf16 v[184:199], v[220:223], v[216:219], v[184:199]
  v_mfma_f32_32x32x16_bf16 v[200:215], v[216:219], v[224:227], v[200:215]
  v_and_b32 v250, 16, v3
  v_add_u32 v250, s5, v250
  ds_read_b128 v[120:123], v250 offset:8192
  ds_read_b128 v[124:127], v250 offset:8224
  ds_read_b128 v[128:131], v250 offset:8256
  ds_read_b128 v[132:135], v250 offset:8288
  v_mov_b32 v234, 0
  v_mov_b32 v235, 0
  v_mov_b32 v253, 0x3f80
  s_nop 1
  v_pk_mul_f32 v[184:185], v[184:185], v[240:241] op_sel:[0,1] op_sel_hi:[1,1]
  v_pk_mul_f32 v[186:187], v[186:187], v[240:241] op_sel:[0,1] op_sel_hi:[1,1]
  v_pk_mul_f32 v[188:189], v[188:189], v[240:241] op_sel:[0,1] op_sel_hi:[1,1]
  v_pk_mul_f32 v[190:191], v[190:191], v[240:241] op_sel:[0,1] op_sel_hi:[1,1]
  v_pk_mul_f32 v[192:193], v[192:193], v[240:241] op_sel:[0,1] op_sel_hi:[1,1]
  v_pk_mul_f32 v[194:195], v[194:195], v[240:241] op_sel:[0,1] op_sel_hi:[1,1]
  v_pk_mul_f32 v[196:197], v[196:197], v[240:241] op_sel:[0,1] op_sel_hi:[1,1]
  v_pk_mul_f32 v[198:199], v[198:199], v[240:241] op_sel:[0,1] op_sel_hi:[1,1]
  v_cvt_pk_bf16_f32 v144, v184, v185
  v_cvt_pk_bf16_f32 v145, v186, v187
  v_cvt_pk_bf16_f32 v146, v188, v189
  v_cvt_pk_bf16_f32 v147, v190, v191
  v_cvt_pk_bf16_f32 v148, v192, v193
  v_cvt_pk_bf16_f32 v149, v194, v195
  v_cvt_pk_bf16_f32 v150, v196, v197
  v_cvt_pk_bf16_f32 v151, v198, v199
  v_bfi_b32 v150, v3, 0, v150
  v_bfi_b32 v151, v3, 0, v151
  buffer_store_dwordx4 v[144:147], v2, s[24:27], s4 offen sc1
  v_dot2c_f32_bf16 v234, v144, v144
  v_dot2c_f32_bf16 v235, v145, v145
  v_dot2c_f32_bf16 v234, v146, v146
  v_dot2c_f32_bf16 v235, v147, v147
  v_dot2c_f32_bf16 v234, v148, v148
  v_dot2c_f32_bf16 v235, v149, v149
  v_dot2c_f32_bf16 v234, v150, v150
  v_dot2c_f32_bf16 v235, v151, v151
  v_bfi_b32 v150, v3, v245, v150
  v_bfi_b32 v151, v3, v253, v151
  buffer_store_dwordx4 v[148:151], v2, s[24:27], s4 offen offset:1024 sc1
  v_mov_b32 v251, v183
  s_waitcnt lgkmcnt(0)
  v_pk_mul_f32 v[200:201], v[200:201], v[120:121]
  v_pk_mul_f32 v[202:203], v[202:203], v[122:123]
  v_pk_mul_f32 v[204:205], v[204:205], v[124:125]
  v_pk_mul_f32 v[206:207], v[206:207], v[126:127]
  v_pk_mul_f32 v[208:209], v[208:209], v[128:129]
  v_pk_mul_f32 v[210:211], v[210:211], v[130:131]
  v_pk_mul_f32 v[212:213], v[212:213], v[132:133]
  v_pk_mul_f32 v[214:215], v[214:215], v[134:135]
  v_cvt_pk_bf16_f32 v176, v200, v201
  v_cvt_pk_bf16_f32 v177, v202, v203
  v_cvt_pk_bf16_f32 v178, v204, v205
  v_cvt_pk_bf16_f32 v179, v206, v207
  v_cvt_pk_bf16_f32 v180, v208, v209
  v_cvt_pk_bf16_f32 v181, v210, v211
  v_cvt_pk_bf16_f32 v182, v212, v213
  v_cvt_pk_bf16_f32 v183, v214, v215
  v_bfi_b32 v176, v4, v5, v176
  v_bfi_b32 v177, v4, v5, v177
  v_bfi_b32 v178, v4, v5, v178
  v_bfi_b32 v179, v4, v5, v179
  buffer_store_dwordx4 v[176:179], v2, s[24:27], s4 offen offset:2048 sc1
  v_bfi_b32 v180, v4, v5, v180
  v_bfi_b32 v181, v4, v5, v181
  v_bfi_b32 v182, v4, v5, v182
  v_bfi_b32 v183, v4, v5, v183
  buffer_store_dwordx4 v[180:183], v2, s[24:27], s4 offen offset:3072 sc1
  v_add_f32 v234, v234, v235
  v_mov_b32 v248, v234
  s_nop 1
  v_permlane32_swap_b32 v248, v234
  v_add_f32 v234, v234, v248
  v_mov_b32 v242, 0
  v_mov_b32 v243, 0
  v_add_u32 v172, 57344, v172
  v_add_u32 v173, 57344, v173
  v_add_u32 v174, 57344, v174
  v_add_u32 v175, 57344, v175
  v_max_f32_dpp v234, v234, v234 row_ror:8 row_mask:0xf bank_mask:0xf
  s_nop 1
  v_max_f32_dpp v234, v234, v234 row_ror:4 row_mask:0xf bank_mask:0xf
  s_nop 1
  v_max_f32_dpp v234, v234, v234 row_ror:2 row_mask:0xf bank_mask:0xf
  s_nop 1
  v_max_f32_dpp v234, v234, v234 row_ror:1 row_mask:0xf bank_mask:0xf
  v_mov_b32 v248, v234
  s_nop 1
  v_permlane16_swap_b32 v248, v234
  v_max_f32 v234, v234, v248
  s_lshl_b32 s50, s3, 2
  s_add_u32 s50, s50, 153088
  v_mov_b32 v248, s50
  ds_write_b32 v248, v234
  v_lshrrev_b32 v248, 5, v0
  v_bfe_u32 v249, v0, 2, 2
  v_lshl_add_u32 v249, v248, 2, v249
  v_lshlrev_b32 v249, 7, v249
  v_bfe_u32 v5, v0, 4, 1
  v_lshl_add_u32 v249, v5, 5, v249
  v_and_b32 v5, 3, v0
  v_lshl_add_u32 v249, v5, 3, v249
  v_add_u32 v5, s5, v249
  v_add_u32 v250, 153088, v1
  v_mul_f32 v241, 0x3e8b97f6, v241
  s_lshl_b32 s51, s38, 11
  s_add_u32 s51, s51, 3932160
  s_lshl_b32 s68, s38, 18
  s_add_u32 s68, s68, 4194304
  s_lshl_b32 s69, s3, 12
  s_add_u32 s69, s69, s68
  s_lshl_b32 s70, s39, 14
  s_add_u32 s70, s70, 0x4000
  s_and_b32 s70, s70, 0x3ffff
  s_add_u32 s53, s69, s70
  s_add_u32 s70, s70, 0x4000
  s_and_b32 s70, s70, 0x3ffff
  s_add_u32 s54, s69, s70
  s_add_u32 s70, s70, 0x4000
  s_and_b32 s70, s70, 0x3ffff
  s_add_u32 s55, s69, s70
  s_add_u32 s70, s70, 0x4000
  s_and_b32 s70, s70, 0x3ffff
  s_add_u32 s56, s69, s70
  s_add_u32 s70, s70, 0x4000
  s_and_b32 s70, s70, 0x3ffff
  s_add_u32 s57, s69, s70
  s_add_u32 s70, s70, 0x4000
  s_and_b32 s70, s70, 0x3ffff
  s_add_u32 s58, s69, s70
  s_add_u32 s70, s70, 0x4000
  s_and_b32 s70, s70, 0x3ffff
  s_add_u32 s59, s69, s70
  s_add_u32 s70, s70, 0x4000
  s_and_b32 s70, s70, 0x3ffff
  s_add_u32 s60, s69, s70
  s_add_u32 s70, s70, 0x4000
  s_and_b32 s70, s70, 0x3ffff
  s_add_u32 s61, s69, s70
  s_add_u32 s70, s70, 0x4000
  s_and_b32 s70, s70, 0x3ffff
  s_add_u32 s62, s69, s70
  s_add_u32 s70, s70, 0x4000
  s_and_b32 s70, s70, 0x3ffff
  s_add_u32 s63, s69, s70
  s_waitcnt vmcnt(9)
  s_barrier
  ds_read_b64_tr_b16 v[220:221], v172 offset:0
  ds_read_b64_tr_b16 v[222:223], v172 offset:256
  ds_read_b64_tr_b16 v[224:225], v173 offset:0
  ds_read_b64_tr_b16 v[226:227], v173 offset:256
  ds_read_b64_tr_b16 v[228:229], v174 offset:0
  ds_read_b64_tr_b16 v[230:231], v174 offset:256
  ds_read_b64_tr_b16 v[236:237], v175 offset:0
  ds_read_b64_tr_b16 v[238:239], v175 offset:256
  ds_read_b64_tr_b16 v[160:161], v172 offset:4096
  ds_read_b64_tr_b16 v[162:163], v172 offset:4352
  s_waitcnt lgkmcnt(8)
  v_mfma_f32_32x32x16_bf16 v[120:135], v[220:223], v[8:11], 0
  ds_read_b64_tr_b16 v[164:165], v173 offset:4096
  ds_read_b64_tr_b16 v[166:167], v173 offset:4352
  ds_read_b64_tr_b16 v[136:137], v172 offset:0
  ds_read_b64_tr_b16 v[138:139], v172 offset:256
  s_add_u32 s70, s70, 0x4000
  s_and_b32 s70, s70, 0x3ffff
  s_add_u32 s64, s69, s70
  s_add_u32 s70, s70, 0x4000
  s_and_b32 s70, s70, 0x3ffff
  s_waitcnt lgkmcnt(10)
  v_mfma_f32_32x32x16_bf16 v[120:135], v[224:227], v[12:15], v[120:135]
  ds_read_b64_tr_b16 v[220:221], v174 offset:4096
  ds_read_b64_tr_b16 v[222:223], v174 offset:4352
  ds_read_b64_tr_b16 v[140:141], v172 offset:4096
  ds_read_b64_tr_b16 v[142:143], v172 offset:4352
  s_add_u32 s65, s69, s70
  s_add_u32 s70, s70, 0x4000
  s_and_b32 s70, s70, 0x3ffff
  s_add_u32 s66, s69, s70
  s_add_u32 s70, s70, 0x4000
  s_waitcnt lgkmcnt(12)
  v_mfma_f32_32x32x16_bf16 v[120:135], v[228:231], v[16:19], v[120:135]
  ds_read_b64_tr_b16 v[224:225], v175 offset:4096
  ds_read_b64_tr_b16 v[226:227], v175 offset:4352
  ds_read_b64_tr_b16 v[152:153], v172 offset:8192
  s_waitcnt lgkmcnt(12)
  ds_read_b64_tr_b16 v[154:155], v172 offset:8448
  s_waitcnt lgkmcnt(8)
  v_dot2c_f32_bf16 v242, v136, v245
  v_dot2c_f32_bf16 v243, v137, v245
  v_dot2c_f32_bf16 v242, v138, v245
  v_dot2c_f32_bf16 v243, v139, v245
  v_mfma_f32_32x32x16_bf16 v[120:135], v[236:239], v[20:23], v[120:135]
  ds_read_b64_tr_b16 v[228:229], v172 offset:8192
  ds_read_b64_tr_b16 v[230:231], v172 offset:8448
  ds_read_b64_tr_b16 v[156:157], v172 offset:12288
  ds_read_b64_tr_b16 v[158:159], v172 offset:12544
  s_waitcnt lgkmcnt(8)
  v_dot2c_f32_bf16 v242, v140, v245
  v_dot2c_f32_bf16 v243, v141, v245
  v_dot2c_f32_bf16 v242, v142, v245
  v_dot2c_f32_bf16 v243, v143, v245
  v_mfma_f32_32x32x16_bf16 v[120:135], v[160:163], v[24:27], v[120:135]
  ds_read_b64_tr_b16 v[236:237], v173 offset:8192
  ds_read_b64_tr_b16 v[238:239], v173 offset:8448
  ds_read_b64_tr_b16 v[136:137], v172 offset:16384
  ds_read_b64_tr_b16 v[138:139], v172 offset:16640
  s_waitcnt lgkmcnt(8)
  v_dot2c_f32_bf16 v242, v152, v245
  v_dot2c_f32_bf16 v243, v153, v245
  v_dot2c_f32_bf16 v242, v154, v245
  v_dot2c_f32_bf16 v243, v155, v245
  v_mfma_f32_32x32x16_bf16 v[120:135], v[164:167], v[28:31], v[120:135]
  ds_read_b64_tr_b16 v[160:161], v174 offset:8192
  ds_read_b64_tr_b16 v[162:163], v174 offset:8448
  ds_read_b64_tr_b16 v[140:141], v172 offset:20480
  ds_read_b64_tr_b16 v[142:143], v172 offset:20736
  s_waitcnt lgkmcnt(8)
  v_dot2c_f32_bf16 v242, v156, v245
  v_dot2c_f32_bf16 v243, v157, v245
  v_dot2c_f32_bf16 v242, v158, v245
  v_dot2c_f32_bf16 v243, v159, v245
  v_mfma_f32_32x32x16_bf16 v[120:135], v[220:223], v[32:35], v[120:135]
  ds_read_b64_tr_b16 v[164:165], v175 offset:8192
  ds_read_b64_tr_b16 v[166:167], v175 offset:8448
  ds_read_b64_tr_b16 v[152:153], v172 offset:24576
  ds_read_b64_tr_b16 v[154:155], v172 offset:24832
  s_waitcnt lgkmcnt(8)
  v_dot2c_f32_bf16 v242, v136, v245
  v_dot2c_f32_bf16 v243, v137, v245
  v_dot2c_f32_bf16 v242, v138, v245
  v_dot2c_f32_bf16 v243, v139, v245
  v_mfma_f32_32x32x16_bf16 v[120:135], v[224:227], v[36:39], v[120:135]
  ds_read_b64_tr_b16 v[220:221], v172 offset:12288
  ds_read_b64_tr_b16 v[222:223], v172 offset:12544
  s_waitcnt lgkmcnt(6)
  v_dot2c_f32_bf16 v242, v140, v245
  v_dot2c_f32_bf16 v243, v141, v245
  v_dot2c_f32_bf16 v242, v142, v245
  v_dot2c_f32_bf16 v243, v143, v245
  v_mfma_f32_32x32x16_bf16 v[120:135], v[228:231], v[40:43], v[120:135]
  ds_read_b64_tr_b16 v[224:225], v173 offset:12288
  ds_read_b64_tr_b16 v[226:227], v173 offset:12544
  s_waitcnt lgkmcnt(4)
  v_dot2c_f32_bf16 v242, v152, v245
  v_dot2c_f32_bf16 v243, v153, v245
  v_dot2c_f32_bf16 v242, v154, v245
  v_dot2c_f32_bf16 v243, v155, v245
  v_mfma_f32_32x32x16_bf16 v[120:135], v[236:239], v[44:47], v[120:135]
  ds_read_b64_tr_b16 v[228:229], v174 offset:12288
  ds_read_b64_tr_b16 v[230:231], v174 offset:12544
  v_add_f32 v242, v242, v243
  v_mov_b32 v248, v242
  s_nop 1
  v_permlane32_swap_b32 v248, v242
  v_add_f32 v242, v242, v248
  ds_write_b32 v251, v242 offset:1024
  v_mfma_f32_32x32x16_bf16 v[120:135], v[160:163], v[48:51], v[120:135]
  ds_read_b64_tr_b16 v[236:237], v175 offset:12288
  ds_read_b64_tr_b16 v[238:239], v175 offset:12544
  s_waitcnt vmcnt(4)
  ds_write_b128 v7, a[0:3] offset:0
  ds_write_b128 v7, a[4:7] offset:1024
  ds_write_b128 v7, a[8:11] offset:2048
  ds_write_b128 v7, a[12:15] offset:3072
  v_mfma_f32_32x32x16_bf16 v[120:135], v[164:167], v[52:55], v[120:135]
  ds_read_b64_tr_b16 v[160:161], v172 offset:16384
  ds_read_b64_tr_b16 v[162:163], v172 offset:16640
  s_mov_b32 s50, 0
Lnon_sequential_preLN__mha_block__dense_activation_silu__prompt_kernel_1:
  v_readfirstlane_b32 s40, v246
  v_readfirstlane_b32 s41, v247
  s_add_u32 s50, s50, 1
  s_cmp_lg_u32 s40, 0
  s_cbranch_scc1 Lnono_sequential_preLN__mha_block__dense_activation_silu__prompt_kernel_2
  s_cmp_ge_u32 s50, 200000
  s_cbranch_scc1 Lnono_sequential_preLN__mha_block__dense_activation_silu__prompt_kernel_2
  s_mov_b64 exec, 1
  global_load_dwordx2 v[246:247], v1, s[18:19] sc1
  s_mov_b64 exec, -1
  s_waitcnt vmcnt(0)
  s_branch Lnon_sequential_preLN__mha_block__dense_activation_silu__prompt_kernel_1
Lnono_sequential_preLN__mha_block__dense_activation_silu__prompt_kernel_2:
  v_mov_b32 v232, s40
  v_mov_b32 v233, s41
  s_waitcnt lgkmcnt(13)
  v_mfma_f32_32x32x16_bf16 v[120:135], v[220:223], v[56:59], v[120:135]
  ds_read_b64_tr_b16 v[164:165], v173 offset:16384
  ds_read_b64_tr_b16 v[166:167], v173 offset:16640
  s_waitcnt lgkmcnt(10)
  s_waitcnt vmcnt(0)
  s_barrier
  s_cmp_lg_u32 s3, 0
  s_cbranch_scc1 Lpub_sequential_preLN__mha_block__dense_activation_silu__prompt_kernel_3
  s_mov_b64 exec, 0x3
  ds_read_b64 v[234:235], v250
  s_nop 0
  s_waitcnt lgkmcnt(0)
  buffer_store_dwordx4 v[232:235], v2, s[24:27], s6 offen sc1
  s_mov_b64 exec, -1
Lpub_sequential_preLN__mha_block__dense_activation_silu__prompt_kernel_3:
  ds_read_b128 v[184:187], v254 offset:1024
  v_mfma_f32_32x32x16_bf16 v[120:135], v[224:227], v[60:63], v[120:135]
  ds_read_b64_tr_b16 v[220:221], v174 offset:16384
  ds_read_b64_tr_b16 v[222:223], v174 offset:16640
  ds_read_b64_tr_b16 v[200:201], v5 offset:0
  ds_read_b64_tr_b16 v[202:203], v5 offset:1024
  s_waitcnt lgkmcnt(12)
  ds_read_b64_tr_b16 v[204:205], v5 offset:2048
  ds_read_b64_tr_b16 v[206:207], v5 offset:3072
  ds_read_b64_tr_b16 v[208:209], v5 offset:64
  s_waitcnt lgkmcnt(12)
  ds_read_b64_tr_b16 v[210:211], v5 offset:1088
  ds_read_b64_tr_b16 v[212:213], v5 offset:2112
  ds_read_b64_tr_b16 v[214:215], v5 offset:3136
  s_and_b32 s70, s70, 0x3ffff
  s_add_u32 s67, s69, s70
  s_mov_b32 s49, s68
  s_mov_b32 s32, s20
  s_mov_b32 s33, s21
  v_mfma_f32_32x32x16_bf16 v[120:135], v[228:231], v[64:67], v[120:135]
  s_waitcnt lgkmcnt(12)
  ds_read_b64_tr_b16 v[224:225], v175 offset:16384
  ds_read_b64_tr_b16 v[226:227], v175 offset:16640
  s_waitcnt lgkmcnt(8)
  buffer_store_dwordx4 v[200:203], v2, s[24:27], s22 offen offset:0 sc1
  s_waitcnt lgkmcnt(6)
  buffer_store_dwordx4 v[204:207], v2, s[24:27], s22 offen offset:1024 sc1
  s_waitcnt lgkmcnt(4)
  buffer_store_dwordx4 v[208:211], v2, s[24:27], s23 offen offset:0 sc1
  s_waitcnt lgkmcnt(2)
  buffer_store_dwordx4 v[212:215], v2, s[24:27], s23 offen offset:1024 sc1
  s_cmp_lt_u32 s37, 28
  s_cselect_b32 s34, 0x1340000, 0
  s_mov_b32 s35, 0x00020000
  s_xor_b32 s50, s12, 1
  s_lshl_b32 s68, s12, 15
  v_mfma_f32_32x32x16_bf16 v[120:135], v[236:239], v[68:71], v[120:135]
  ds_read_b64_tr_b16 v[228:229], v172 offset:20480
  ds_read_b64_tr_b16 v[230:231], v172 offset:20736
  v_add_f32 v184, v184, v185
  v_add_f32 v186, v186, v187
  v_add_f32 v242, v184, v186
  v_mov_b32 v190, 0
  v_mov_b32 v191, 0
  v_and_b32 v248, 0xffff0000, v242
  v_sub_f32 v249, v242, v248
  v_cvt_pk_bf16_f32 v188, v248, v249
  v_lshrrev_b32 v189, 16, v248
  s_lshl_b32 s69, s50, 15
  s_lshl_b32 s72, s3, 13
  s_add_u32 s72, s72, 0
  s_add_u32 s68, s68, s72
  s_add_u32 s69, s69, s72
  v_mfma_f32_32x32x16_bf16 v[120:135], v[160:163], v[72:75], v[120:135]
  ds_read_b64_tr_b16 v[236:237], v173 offset:20480
  ds_read_b64_tr_b16 v[238:239], v173 offset:20736
  v_mfma_f32_32x32x16_bf16 v[120:135], v[188:191], v[216:219], v[120:135]
  s_mul_i32 s70, s12, 114688
  s_mul_i32 s71, s50, 114688
  s_lshr_b32 s72, s3, 1
  s_lshl_b32 s72, s72, 13
  s_and_b32 s14, s3, 1
  v_mfma_f32_32x32x16_bf16 v[120:135], v[164:167], v[76:79], v[120:135]
  ds_read_b64_tr_b16 v[160:161], v174 offset:20480
  ds_read_b64_tr_b16 v[162:163], v174 offset:20736
  s_lshl_b32 s14, s14, 10
  s_add_u32 s14, s14, s72
  s_add_u32 s72, s14, 2064384
  s_add_u32 s70, s70, s72
  s_add_u32 s71, s71, s72
  v_mfma_f32_32x32x16_bf16 v[120:135], v[220:223], v[80:83], v[120:135]
  ds_read_b64_tr_b16 v[164:165], v175 offset:20480
  ds_read_b64_tr_b16 v[166:167], v175 offset:20736
  s_add_u32 s8, s70, 4096
  s_add_u32 s9, s71, 4096
  s_mul_i32 s72, s46, 114688
  s_mul_i32 s52, s3, 7168
  s_add_u32 s72, s72, s52
  s_waitcnt lgkmcnt(8)
  v_mfma_f32_32x32x16_bf16 v[120:135], v[224:227], v[84:87], v[120:135]
  ds_read_b64_tr_b16 v[220:221], v172 offset:24576
  ds_read_b64_tr_b16 v[222:223], v172 offset:24832
  s_add_u32 s72, s72, 458752
  s_add_u32 s10, s72, 28672
  s_add_u32 s74, s72, 57344
  s_add_u32 s75, s72, 86016
  s_mov_b32 m0, s52
  s_waitcnt lgkmcnt(8)
  v_mfma_f32_32x32x16_bf16 v[120:135], v[228:231], v[88:91], v[120:135]
  ds_read_b64_tr_b16 v[224:225], v173 offset:24576
  ds_read_b64_tr_b16 v[226:227], v173 offset:24832
  s_mul_i32 s11, s13, 28672
  s_lshl_b32 s50, s12, 6
  s_add_u32 s11, s11, s50
  v_xor_b32 v251, 16384, v7
  v_xor_b32 v252, 32768, v7
  s_waitcnt lgkmcnt(8)
  v_mfma_f32_32x32x16_bf16 v[120:135], v[236:239], v[92:95], v[120:135]
  ds_read_b64_tr_b16 v[228:229], v174 offset:24576
  ds_read_b64_tr_b16 v[230:231], v174 offset:24832
  v_xor_b32 v253, 49152, v7
  v_mov_b32 v248, 0
  v_mov_b32 v249, 0
  s_waitcnt lgkmcnt(8)
  v_mfma_f32_32x32x16_bf16 v[120:135], v[160:163], v[96:99], v[120:135]
  ds_read_b64_tr_b16 v[236:237], v175 offset:24576
  ds_read_b64_tr_b16 v[238:239], v175 offset:24832
  s_waitcnt lgkmcnt(8)
  v_mfma_f32_32x32x16_bf16 v[120:135], v[164:167], v[100:103], v[120:135]
  s_waitcnt lgkmcnt(6)
  v_mfma_f32_32x32x16_bf16 v[120:135], v[220:223], v[104:107], v[120:135]
  s_cmp_lg_u32 s3, 3
  s_cbranch_scc1 Le0_sequential_preLN__mha_block__dense_activation_silu__prompt_kernel_4
  v_lshrrev_b32 v210, 1, v0
  v_lshlrev_b32 v210, 7, v210
  v_and_b32 v209, 1, v0
  v_lshl_add_u32 v210, v209, 4, v210
  v_mov_b32 v194, 0
  v_mov_b32 v195, 0
  s_mov_b64 exec, 0xffffffff
  buffer_load_dwordx4 v[192:195], v210, s[24:27], s51 offen sc1
  s_mov_b64 exec, -1
Le0_sequential_preLN__mha_block__dense_activation_silu__prompt_kernel_4:
  s_waitcnt lgkmcnt(4)
  v_mfma_f32_32x32x16_bf16 v[120:135], v[224:227], v[108:111], v[120:135]
  s_waitcnt lgkmcnt(2)
  v_mfma_f32_32x32x16_bf16 v[120:135], v[228:231], v[112:115], v[120:135]
  s_waitcnt lgkmcnt(0)
  v_mfma_f32_32x32x16_bf16 v[120:135], v[236:239], v[116:119], v[120:135]
  s_nop 11
  v_pk_mul_f32 v[120:121], v[120:121], v[240:241] op_sel:[0,1] op_sel_hi:[1,1]
  v_pk_mul_f32 v[122:123], v[122:123], v[240:241] op_sel:[0,1] op_sel_hi:[1,1]
  v_pk_mul_f32 v[124:125], v[124:125], v[240:241] op_sel:[0,1] op_sel_hi:[1,1]
  v_pk_mul_f32 v[126:127], v[126:127], v[240:241] op_sel:[0,1] op_sel_hi:[1,1]
  v_pk_mul_f32 v[128:129], v[128:129], v[240:241] op_sel:[0,1] op_sel_hi:[1,1]
  v_pk_mul_f32 v[130:131], v[130:131], v[240:241] op_sel:[0,1] op_sel_hi:[1,1]
  v_pk_mul_f32 v[132:133], v[132:133], v[240:241] op_sel:[0,1] op_sel_hi:[1,1]
  v_pk_mul_f32 v[134:135], v[134:135], v[240:241] op_sel:[0,1] op_sel_hi:[1,1]
  v_cvt_pk_bf16_f32 v8, v120, v121
  v_cvt_pk_bf16_f32 v9, v122, v123
  v_cvt_pk_bf16_f32 v10, v124, v125
  v_cvt_pk_bf16_f32 v11, v126, v127
  v_cvt_pk_bf16_f32 v12, v128, v129
  v_cvt_pk_bf16_f32 v13, v130, v131
  v_cvt_pk_bf16_f32 v14, v132, v133
  v_cvt_pk_bf16_f32 v15, v134, v135
  v_bfi_b32 v14, v3, 0, v14
  v_bfi_b32 v15, v3, 0, v15
  ds_write_b128 v7, v[8:11] offset:12288
  v_dot2c_f32_bf16 v248, v8, v8
  v_dot2c_f32_bf16 v249, v9, v9
  v_dot2c_f32_bf16 v248, v10, v10
  v_dot2c_f32_bf16 v249, v11, v11
  v_dot2c_f32_bf16 v248, v12, v12
  v_dot2c_f32_bf16 v249, v13, v13
  v_dot2c_f32_bf16 v248, v14, v14
  v_dot2c_f32_bf16 v249, v15, v15
  s_nop 2
  v_add_f32 v248, v248, v249
  v_mov_b32 v249, v248
  s_nop 1
  v_permlane32_swap_b32 v249, v248
  v_add_f32 v248, v248, v249
  v_sqrt_f32 v248, v248
  s_nop 0
  v_mul_f32 v248, 0x3f828f5c, v248
  v_cvt_pk_bf16_f32 v248, v248, 0
  v_bfi_b32 v14, v3, v248, v14
  ds_write_b128 v7, v[12:15] offset:13312
  s_waitcnt vmcnt(0)
  s_waitcnt lgkmcnt(0)
  s_barrier
  ds_read_b128 v[16:19], v251 offset:12288
  ds_read_b128 v[20:23], v251 offset:13312
  ds_read_b128 v[24:27], v252 offset:12288
  ds_read_b128 v[28:31], v252 offset:13312
  ds_read_b128 v[32:35], v253 offset:12288
  ds_read_b128 v[36:39], v253 offset:13312
  s_cmp_lg_u32 s3, 0
  s_cbranch_scc1 Lpub_sequential_preLN__mha_block__dense_activation_silu__prompt_kernel_5
  s_mov_b64 exec, 0x1
  buffer_store_dwordx2 v[232:233], off, s[24:27], s7  sc1
  s_mov_b64 exec, -1
Lpub_sequential_preLN__mha_block__dense_activation_silu__prompt_kernel_5:
  v_add_u32 v216, 4096, v2
  v_add_u32 v217, 16384, v2
  v_add_u32 v218, 32768, v2
  v_add_u32 v219, 49152, v2
  v_add_u32 v220, 65536, v2
  v_add_u32 v221, 81920, v2
  v_add_u32 v222, 98304, v2
  s_waitcnt lgkmcnt(0)
  v_mov_b32 v211, 153152
  s_cmp_lg_u32 s3, 3
  s_cbranch_scc1 Lpolls_sequential_preLN__mha_block__dense_activation_silu__prompt_kernel_8
  s_mov_b64 exec, 0xffffffff
  s_mov_b32 s50, 0
  s_waitcnt vmcnt(0)
  v_cmp_ne_u64 vcc, s[40:41], v[192:193]
  s_nop 4
  s_cbranch_vccz Lpollo_sequential_preLN__mha_block__dense_activation_silu__prompt_kernel_7
Lpoll_sequential_preLN__mha_block__dense_activation_silu__prompt_kernel_6:
  buffer_load_dwordx4 v[192:195], v210, s[24:27], s51 offen sc1
  s_add_u32 s50, s50, 1
  s_waitcnt vmcnt(0)
  v_cmp_ne_u64 vcc, s[40:41], v[192:193]
  s_cmp_ge_u32 s50, 200000
  s_cbranch_scc1 Lpollo_sequential_preLN__mha_block__dense_activation_silu__prompt_kernel_7
  s_nop 2
  s_cbranch_vccnz Lpoll_sequential_preLN__mha_block__dense_activation_silu__prompt_kernel_6
Lpollo_sequential_preLN__mha_block__dense_activation_silu__prompt_kernel_7:
  s_mov_b64 exec, -1
  v_max_f32 v208, v194, v195
  s_nop 1
  v_max_f32_dpp v208, v208, v208 row_ror:8 row_mask:0xf bank_mask:0xf
  s_nop 1
  v_max_f32_dpp v208, v208, v208 row_ror:4 row_mask:0xf bank_mask:0xf
  s_nop 1
  v_max_f32_dpp v208, v208, v208 row_ror:2 row_mask:0xf bank_mask:0xf
  s_nop 1
  v_max_f32_dpp v208, v208, v208 row_ror:1 row_mask:0xf bank_mask:0xf
  v_mov_b32 v209, v208
  s_nop 1
  v_permlane16_swap_b32 v209, v208
  v_max_f32 v208, v208, v209
  v_sqrt_f32 v208, v208
  s_nop 0
  v_mul_f32 v208, 0xbf828f5c, v208
  s_mov_b64 exec, 1
  ds_write_b32 v211, v208
  s_mov_b64 exec, -1
  s_waitcnt lgkmcnt(0)
Lpolls_sequential_preLN__mha_block__dense_activation_silu__prompt_kernel_8:
  s_barrier
  ds_read_b32 v208, v211
  buffer_load_dwordx4 v[152:155], v2, s[24:27], s53 offen offset:0 sc1
  buffer_load_dwordx4 v[156:159], v2, s[24:27], s53 offen offset:1024 sc1
  buffer_load_dwordx4 v[184:187], v2, s[24:27], s53 offen offset:2048 sc1
  buffer_load_dwordx4 v[188:191], v2, s[24:27], s53 offen offset:3072 sc1
  v_lshlrev_b32 v120, 16, v14
  v_lshlrev_b32 v121, 16, v22
  v_lshlrev_b32 v122, 16, v30
  v_lshlrev_b32 v123, 16, v38
  s_waitcnt lgkmcnt(0)
  v_mul_f32 v120, v120, v208
  v_cvt_pk_bf16_f32 v120, v120, 0
  v_bfi_b32 v14, v3, v120, v14
  v_mul_f32 v121, v121, v208
  v_cvt_pk_bf16_f32 v121, v121, 0
  v_bfi_b32 v22, v3, v121, v22
  v_mul_f32 v122, v122, v208
  v_cvt_pk_bf16_f32 v122, v122, 0
  v_bfi_b32 v30, v3, v122, v30
  v_mul_f32 v123, v123, v208
  v_cvt_pk_bf16_f32 v123, v123, 0
  v_bfi_b32 v38, v3, v123, v38
  v_and_b32 v6, 31, v0
  v_mul_u32_u24 v6, 896, v6
  v_and_b32 v7, 16, v3
  v_add_u32 v6, v6, v7
  v_mfma_f32_32x32x16_bf16 v[104:119], v[144:147], v[8:11], 0
  v_mfma_f32_32x32x16_bf16 v[104:119], v[148:151], v[12:15], v[104:119]
  buffer_load_dwordx4 v[160:163], v2, s[24:27], s54 offen offset:0 sc1
  buffer_load_dwordx4 v[164:167], v2, s[24:27], s54 offen offset:1024 sc1
  buffer_load_dwordx4 v[192:195], v2, s[24:27], s54 offen offset:2048 sc1
  buffer_load_dwordx4 v[196:199], v2, s[24:27], s54 offen offset:3072 sc1
  buffer_load_dwordx4 v[168:171], v2, s[24:27], s55 offen offset:0 sc1
  buffer_load_dwordx4 v[172:175], v2, s[24:27], s55 offen offset:1024 sc1
  buffer_load_dwordx4 v[200:203], v2, s[24:27], s55 offen offset:2048 sc1
  buffer_load_dwordx4 v[204:207], v2, s[24:27], s55 offen offset:3072 sc1
  s_lshl_b32 s50, s3, 12
  s_add_u32 s50, s50, 114688
  v_add_u32 v5, s50, v2
  v_mfma_f32_32x32x16_bf16 v[120:135], v[144:147], v[16:19], 0
  v_exp_f32 v104, v104
  v_exp_f32 v105, v105
  v_exp_f32 v106, v106
  v_exp_f32 v107, v107
  v_cvt_pk_bf16_f32 v136, v104, v105
  v_cvt_pk_bf16_f32 v137, v106, v107
  v_exp_f32 v108, v108
  v_exp_f32 v109, v109
  v_exp_f32 v110, v110
  v_exp_f32 v111, v111
  v_cvt_pk_bf16_f32 v138, v108, v109
  v_cvt_pk_bf16_f32 v139, v110, v111
  v_mfma_f32_32x32x16_bf16 v[120:135], v[148:151], v[20:23], v[120:135]
  v_exp_f32 v112, v112
  v_exp_f32 v113, v113
  v_exp_f32 v114, v114
  v_exp_f32 v115, v115
  v_cvt_pk_bf16_f32 v140, v112, v113
  v_cvt_pk_bf16_f32 v141, v114, v115
  v_mfma_f32_32x32x16_bf16 v[40:55], v[176:179], v[136:139], 0
  v_exp_f32 v116, v116
  v_exp_f32 v117, v117
  v_exp_f32 v118, v118
  v_exp_f32 v119, v119
  v_cvt_pk_bf16_f32 v142, v116, v117
  v_cvt_pk_bf16_f32 v143, v118, v119
  v_mfma_f32_32x32x16_bf16 v[104:119], v[144:147], v[24:27], 0
  v_exp_f32 v120, v120
  v_exp_f32 v121, v121
  v_exp_f32 v122, v122
  v_exp_f32 v123, v123
  v_cvt_pk_bf16_f32 v136, v120, v121
  v_cvt_pk_bf16_f32 v137, v122, v123
  v_mfma_f32_32x32x16_bf16 v[40:55], v[180:183], v[140:143], v[40:55]
  v_exp_f32 v124, v124
  v_exp_f32 v125, v125
  v_exp_f32 v126, v126
  v_exp_f32 v127, v127
  v_cvt_pk_bf16_f32 v138, v124, v125
  v_cvt_pk_bf16_f32 v139, v126, v127
  v_mfma_f32_32x32x16_bf16 v[104:119], v[148:151], v[28:31], v[104:119]
  v_exp_f32 v128, v128
  v_exp_f32 v129, v129
  v_exp_f32 v130, v130
  v_exp_f32 v131, v131
  v_cvt_pk_bf16_f32 v140, v128, v129
  v_cvt_pk_bf16_f32 v141, v130, v131
  v_mfma_f32_32x32x16_bf16 v[56:71], v[176:179], v[136:139], 0
  v_exp_f32 v132, v132
  v_exp_f32 v133, v133
  v_exp_f32 v134, v134
  v_exp_f32 v135, v135
  v_cvt_pk_bf16_f32 v142, v132, v133
  v_cvt_pk_bf16_f32 v143, v134, v135
  v_mfma_f32_32x32x16_bf16 v[120:135], v[144:147], v[32:35], 0
  v_exp_f32 v104, v104
  v_exp_f32 v105, v105
  v_exp_f32 v106, v106
  v_exp_f32 v107, v107
  v_cvt_pk_bf16_f32 v136, v104, v105
  v_cvt_pk_bf16_f32 v137, v106, v107
  v_mfma_f32_32x32x16_bf16 v[56:71], v[180:183], v[140:143], v[56:71]
  v_exp_f32 v108, v108
  v_exp_f32 v109, v109
  v_exp_f32 v110, v110
  v_exp_f32 v111, v111
  v_cvt_pk_bf16_f32 v138, v108, v109
  v_cvt_pk_bf16_f32 v139, v110, v111
  v_mfma_f32_32x32x16_bf16 v[120:135], v[148:151], v[36:39], v[120:135]
  v_exp_f32 v112, v112
  v_exp_f32 v113, v113
  v_exp_f32 v114, v114
  v_exp_f32 v115, v115
  v_cvt_pk_bf16_f32 v140, v112, v113
  v_cvt_pk_bf16_f32 v141, v114, v115
  v_mfma_f32_32x32x16_bf16 v[72:87], v[176:179], v[136:139], 0
  buffer_load_dwordx4 v[144:147], v2, s[24:27], s56 offen offset:0 sc1
  v_exp_f32 v116, v116
  v_exp_f32 v117, v117
  v_exp_f32 v118, v118
  v_exp_f32 v119, v119
  v_cvt_pk_bf16_f32 v142, v116, v117
  v_cvt_pk_bf16_f32 v143, v118, v119
  s_waitcnt vmcnt(9)
  v_mfma_f32_32x32x16_bf16 v[104:119], v[152:155], v[8:11], 0
  buffer_load_dwordx4 v[148:151], v2, s[24:27], s56 offen offset:1024 sc1
  v_exp_f32 v120, v120
  v_exp_f32 v121, v121
  v_exp_f32 v122, v122
  v_exp_f32 v123, v123
  v_cvt_pk_bf16_f32 v136, v120, v121
  v_cvt_pk_bf16_f32 v137, v122, v123
  v_mfma_f32_32x32x16_bf16 v[72:87], v[180:183], v[140:143], v[72:87]
  v_exp_f32 v124, v124
  v_exp_f32 v125, v125
  v_exp_f32 v126, v126
  v_exp_f32 v127, v127
  v_cvt_pk_bf16_f32 v138, v124, v125
  v_cvt_pk_bf16_f32 v139, v126, v127
  v_mfma_f32_32x32x16_bf16 v[104:119], v[156:159], v[12:15], v[104:119]
  v_exp_f32 v128, v128
  v_exp_f32 v129, v129
  v_exp_f32 v130, v130
  v_exp_f32 v131, v131
  v_cvt_pk_bf16_f32 v140, v128, v129
  v_cvt_pk_bf16_f32 v141, v130, v131
  v_mfma_f32_32x32x16_bf16 v[88:103], v[176:179], v[136:139], 0
  v_exp_f32 v132, v132
  v_exp_f32 v133, v133
  v_exp_f32 v134, v134
  v_exp_f32 v135, v135
  v_cvt_pk_bf16_f32 v142, v132, v133
  v_cvt_pk_bf16_f32 v143, v134, v135
  v_mfma_f32_32x32x16_bf16 v[120:135], v[152:155], v[16:19], 0
  v_exp_f32 v104, v104
  v_exp_f32 v105, v105
  v_exp_f32 v106, v106
  v_exp_f32 v107, v107
  v_cvt_pk_bf16_f32 v136, v104, v105
  v_cvt_pk_bf16_f32 v137, v106, v107
  v_mfma_f32_32x32x16_bf16 v[88:103], v[180:183], v[140:143], v[88:103]
  v_exp_f32 v108, v108
  v_exp_f32 v109, v109
  v_exp_f32 v110, v110
  v_exp_f32 v111, v111
  v_cvt_pk_bf16_f32 v138, v108, v109
  v_cvt_pk_bf16_f32 v139, v110, v111
  v_mfma_f32_32x32x16_bf16 v[120:135], v[156:159], v[20:23], v[120:135]
  buffer_load_dwordx4 v[176:179], v2, s[24:27], s56 offen offset:2048 sc1
  v_exp_f32 v112, v112
  v_exp_f32 v113, v113
  v_exp_f32 v114, v114
  v_exp_f32 v115, v115
  v_cvt_pk_bf16_f32 v140, v112, v113
  v_cvt_pk_bf16_f32 v141, v114, v115
  v_mfma_f32_32x32x16_bf16 v[40:55], v[184:187], v[136:139], v[40:55]
  buffer_load_dwordx4 v[180:183], v2, s[24:27], s56 offen offset:3072 sc1
  v_exp_f32 v116, v116
  v_exp_f32 v117, v117
  v_exp_f32 v118, v118
  v_exp_f32 v119, v119
  v_cvt_pk_bf16_f32 v142, v116, v117
  v_cvt_pk_bf16_f32 v143, v118, v119
  v_mfma_f32_32x32x16_bf16 v[104:119], v[152:155], v[24:27], 0
  v_exp_f32 v120, v120
  v_exp_f32 v121, v121
  v_exp_f32 v122, v122
  v_exp_f32 v123, v123
  v_cvt_pk_bf16_f32 v136, v120, v121
  v_cvt_pk_bf16_f32 v137, v122, v123
  v_mfma_f32_32x32x16_bf16 v[40:55], v[188:191], v[140:143], v[40:55]
  v_exp_f32 v124, v124
  v_exp_f32 v125, v125
  v_exp_f32 v126, v126
  v_exp_f32 v127, v127
  v_cvt_pk_bf16_f32 v138, v124, v125
  v_cvt_pk_bf16_f32 v139, v126, v127
  v_mfma_f32_32x32x16_bf16 v[104:119], v[156:159], v[28:31], v[104:119]
  v_exp_f32 v128, v128
  v_exp_f32 v129, v129
  v_exp_f32 v130, v130
  v_exp_f32 v131, v131
  v_cvt_pk_bf16_f32 v140, v128, v129
  v_cvt_pk_bf16_f32 v141, v130, v131
  v_mfma_f32_32x32x16_bf16 v[56:71], v[184:187], v[136:139], v[56:71]
  v_exp_f32 v132, v132
  v_exp_f32 v133, v133
  v_exp_f32 v134, v134
  v_exp_f32 v135, v135
  v_cvt_pk_bf16_f32 v142, v132, v133
  v_cvt_pk_bf16_f32 v143, v134, v135
  v_mfma_f32_32x32x16_bf16 v[120:135], v[152:155], v[32:35], 0
  v_exp_f32 v104, v104
  v_exp_f32 v105, v105
  v_exp_f32 v106, v106
  v_exp_f32 v107, v107
  v_cvt_pk_bf16_f32 v136, v104, v105
  v_cvt_pk_bf16_f32 v137, v106, v107
  v_mfma_f32_32x32x16_bf16 v[56:71], v[188:191], v[140:143], v[56:71]
  v_exp_f32 v108, v108
  v_exp_f32 v109, v109
  v_exp_f32 v110, v110
  v_exp_f32 v111, v111
  v_cvt_pk_bf16_f32 v138, v108, v109
  v_cvt_pk_bf16_f32 v139, v110, v111
  v_mfma_f32_32x32x16_bf16 v[120:135], v[156:159], v[36:39], v[120:135]
  v_exp_f32 v112, v112
  v_exp_f32 v113, v113
  v_exp_f32 v114, v114
  v_exp_f32 v115, v115
  v_cvt_pk_bf16_f32 v140, v112, v113
  v_cvt_pk_bf16_f32 v141, v114, v115
  v_mfma_f32_32x32x16_bf16 v[72:87], v[184:187], v[136:139], v[72:87]
  buffer_load_dwordx4 v[152:155], v2, s[24:27], s57 offen offset:0 sc1
  v_exp_f32 v116, v116
  v_exp_f32 v117, v117
  v_exp_f32 v118, v118
  v_exp_f32 v119, v119
  v_cvt_pk_bf16_f32 v142, v116, v117
  v_cvt_pk_bf16_f32 v143, v118, v119
  s_waitcnt vmcnt(9)
  v_mfma_f32_32x32x16_bf16 v[104:119], v[160:163], v[8:11], 0
  buffer_load_dwordx4 v[156:159], v2, s[24:27], s57 offen offset:1024 sc1
  v_exp_f32 v120, v120
  v_exp_f32 v121, v121
  v_exp_f32 v122, v122
  v_exp_f32 v123, v123
  v_cvt_pk_bf16_f32 v136, v120, v121
  v_cvt_pk_bf16_f32 v137, v122, v123
  v_mfma_f32_32x32x16_bf16 v[72:87], v[188:191], v[140:143], v[72:87]
  v_exp_f32 v124, v124
  v_exp_f32 v125, v125
  v_exp_f32 v126, v126
  v_exp_f32 v127, v127
  v_cvt_pk_bf16_f32 v138, v124, v125
  v_cvt_pk_bf16_f32 v139, v126, v127
  v_mfma_f32_32x32x16_bf16 v[104:119], v[164:167], v[12:15], v[104:119]
  v_exp_f32 v128, v128
  v_exp_f32 v129, v129
  v_exp_f32 v130, v130
  v_exp_f32 v131, v131
  v_cvt_pk_bf16_f32 v140, v128, v129
  v_cvt_pk_bf16_f32 v141, v130, v131
  v_mfma_f32_32x32x16_bf16 v[88:103], v[184:187], v[136:139], v[88:103]
  v_exp_f32 v132, v132
  v_exp_f32 v133, v133
  v_exp_f32 v134, v134
  v_exp_f32 v135, v135
  v_cvt_pk_bf16_f32 v142, v132, v133
  v_cvt_pk_bf16_f32 v143, v134, v135
  v_mfma_f32_32x32x16_bf16 v[120:135], v[160:163], v[16:19], 0
  v_exp_f32 v104, v104
  v_exp_f32 v105, v105
  v_exp_f32 v106, v106
  v_exp_f32 v107, v107
  v_cvt_pk_bf16_f32 v136, v104, v105
  v_cvt_pk_bf16_f32 v137, v106, v107
  v_mfma_f32_32x32x16_bf16 v[88:103], v[188:191], v[140:143], v[88:103]
  v_exp_f32 v108, v108
  v_exp_f32 v109, v109
  v_exp_f32 v110, v110
  v_exp_f32 v111, v111
  v_cvt_pk_bf16_f32 v138, v108, v109
  v_cvt_pk_bf16_f32 v139, v110, v111
  v_mfma_f32_32x32x16_bf16 v[120:135], v[164:167], v[20:23], v[120:135]
  buffer_load_dwordx4 v[184:187], v2, s[24:27], s57 offen offset:2048 sc1
  v_exp_f32 v112, v112
  v_exp_f32 v113, v113
  v_exp_f32 v114, v114
  v_exp_f32 v115, v115
  v_cvt_pk_bf16_f32 v140, v112, v113
  v_cvt_pk_bf16_f32 v141, v114, v115
  v_mfma_f32_32x32x16_bf16 v[40:55], v[192:195], v[136:139], v[40:55]
  buffer_load_dwordx4 v[188:191], v2, s[24:27], s57 offen offset:3072 sc1
  v_exp_f32 v116, v116
  v_exp_f32 v117, v117
  v_exp_f32 v118, v118
  v_exp_f32 v119, v119
  v_cvt_pk_bf16_f32 v142, v116, v117
  v_cvt_pk_bf16_f32 v143, v118, v119
  v_mfma_f32_32x32x16_bf16 v[104:119], v[160:163], v[24:27], 0
  v_exp_f32 v120, v120
  v_exp_f32 v121, v121
  v_exp_f32 v122, v122
  v_exp_f32 v123, v123
  v_cvt_pk_bf16_f32 v136, v120, v121
  v_cvt_pk_bf16_f32 v137, v122, v123
  v_mfma_f32_32x32x16_bf16 v[40:55], v[196:199], v[140:143], v[40:55]
  v_exp_f32 v124, v124
  v_exp_f32 v125, v125
  v_exp_f32 v126, v126
  v_exp_f32 v127, v127
  v_cvt_pk_bf16_f32 v138, v124, v125
  v_cvt_pk_bf16_f32 v139, v126, v127
  v_mfma_f32_32x32x16_bf16 v[104:119], v[164:167], v[28:31], v[104:119]
  v_exp_f32 v128, v128
  v_exp_f32 v129, v129
  v_exp_f32 v130, v130
  v_exp_f32 v131, v131
  v_cvt_pk_bf16_f32 v140, v128, v129
  v_cvt_pk_bf16_f32 v141, v130, v131
  v_mfma_f32_32x32x16_bf16 v[56:71], v[192:195], v[136:139], v[56:71]
  v_exp_f32 v132, v132
  v_exp_f32 v133, v133
  v_exp_f32 v134, v134
  v_exp_f32 v135, v135
  v_cvt_pk_bf16_f32 v142, v132, v133
  v_cvt_pk_bf16_f32 v143, v134, v135
  v_mfma_f32_32x32x16_bf16 v[120:135], v[160:163], v[32:35], 0
  v_exp_f32 v104, v104
  v_exp_f32 v105, v105
  v_exp_f32 v106, v106
  v_exp_f32 v107, v107
  v_cvt_pk_bf16_f32 v136, v104, v105
  v_cvt_pk_bf16_f32 v137, v106, v107
  v_mfma_f32_32x32x16_bf16 v[56:71], v[196:199], v[140:143], v[56:71]
  v_exp_f32 v108, v108
  v_exp_f32 v109, v109
  v_exp_f32 v110, v110
  v_exp_f32 v111, v111
  v_cvt_pk_bf16_f32 v138, v108, v109
  v_cvt_pk_bf16_f32 v139, v110, v111
  v_mfma_f32_32x32x16_bf16 v[120:135], v[164:167], v[36:39], v[120:135]
  v_exp_f32 v112, v112
  v_exp_f32 v113, v113
  v_exp_f32 v114, v114
  v_exp_f32 v115, v115
  v_cvt_pk_bf16_f32 v140, v112, v113
  v_cvt_pk_bf16_f32 v141, v114, v115
  v_mfma_f32_32x32x16_bf16 v[72:87], v[192:195], v[136:139], v[72:87]
  buffer_load_dwordx4 v[160:163], v2, s[24:27], s58 offen offset:0 sc1
  v_exp_f32 v116, v116
  v_exp_f32 v117, v117
  v_exp_f32 v118, v118
  v_exp_f32 v119, v119
  v_cvt_pk_bf16_f32 v142, v116, v117
  v_cvt_pk_bf16_f32 v143, v118, v119
  s_waitcnt vmcnt(9)
  v_mfma_f32_32x32x16_bf16 v[104:119], v[168:171], v[8:11], 0
  buffer_load_dwordx4 v[164:167], v2, s[24:27], s58 offen offset:1024 sc1
  v_exp_f32 v120, v120
  v_exp_f32 v121, v121
  v_exp_f32 v122, v122
  v_exp_f32 v123, v123
  v_cvt_pk_bf16_f32 v136, v120, v121
  v_cvt_pk_bf16_f32 v137, v122, v123
  v_mfma_f32_32x32x16_bf16 v[72:87], v[196:199], v[140:143], v[72:87]
  v_exp_f32 v124, v124
  v_exp_f32 v125, v125
  v_exp_f32 v126, v126
  v_exp_f32 v127, v127
  v_cvt_pk_bf16_f32 v138, v124, v125
  v_cvt_pk_bf16_f32 v139, v126, v127
  v_mfma_f32_32x32x16_bf16 v[104:119], v[172:175], v[12:15], v[104:119]
  v_exp_f32 v128, v128
  v_exp_f32 v129, v129
  v_exp_f32 v130, v130
  v_exp_f32 v131, v131
  v_cvt_pk_bf16_f32 v140, v128, v129
  v_cvt_pk_bf16_f32 v141, v130, v131
  v_mfma_f32_32x32x16_bf16 v[88:103], v[192:195], v[136:139], v[88:103]
  v_exp_f32 v132, v132
  v_exp_f32 v133, v133
  v_exp_f32 v134, v134
  v_exp_f32 v135, v135
  v_cvt_pk_bf16_f32 v142, v132, v133
  v_cvt_pk_bf16_f32 v143, v134, v135
  v_mfma_f32_32x32x16_bf16 v[120:135], v[168:171], v[16:19], 0
  s_mov_b32 s51, 4096000
  v_exp_f32 v104, v104
  v_exp_f32 v105, v105
  v_exp_f32 v106, v106
  v_exp_f32 v107, v107
  v_cvt_pk_bf16_f32 v136, v104, v105
  v_cvt_pk_bf16_f32 v137, v106, v107
  v_mfma_f32_32x32x16_bf16 v[88:103], v[196:199], v[140:143], v[88:103]
  buffer_load_dwordx4 v[208:211], v2, s[24:27], s51 offen offset:0 sc1
  v_exp_f32 v108, v108
  v_exp_f32 v109, v109
  v_exp_f32 v110, v110
  v_exp_f32 v111, v111
  v_cvt_pk_bf16_f32 v138, v108, v109
  v_cvt_pk_bf16_f32 v139, v110, v111
  v_mfma_f32_32x32x16_bf16 v[120:135], v[172:175], v[20:23], v[120:135]
  buffer_load_dwordx4 v[192:195], v2, s[24:27], s58 offen offset:2048 sc1
  v_exp_f32 v112, v112
  v_exp_f32 v113, v113
  v_exp_f32 v114, v114
  v_exp_f32 v115, v115
  v_cvt_pk_bf16_f32 v140, v112, v113
  v_cvt_pk_bf16_f32 v141, v114, v115
  v_mfma_f32_32x32x16_bf16 v[40:55], v[200:203], v[136:139], v[40:55]
  buffer_load_dwordx4 v[196:199], v2, s[24:27], s58 offen offset:3072 sc1
  v_exp_f32 v116, v116
  v_exp_f32 v117, v117
  v_exp_f32 v118, v118
  v_exp_f32 v119, v119
  v_cvt_pk_bf16_f32 v142, v116, v117
  v_cvt_pk_bf16_f32 v143, v118, v119
  v_mfma_f32_32x32x16_bf16 v[104:119], v[168:171], v[24:27], 0
  buffer_load_dwordx4 v[212:215], v2, s[24:27], s51 offen offset:768 sc1
  v_exp_f32 v120, v120
  v_exp_f32 v121, v121
  v_exp_f32 v122, v122
  v_exp_f32 v123, v123
  v_cvt_pk_bf16_f32 v136, v120, v121
  v_cvt_pk_bf16_f32 v137, v122, v123
  v_mfma_f32_32x32x16_bf16 v[40:55], v[204:207], v[140:143], v[40:55]
  v_exp_f32 v124, v124
  v_exp_f32 v125, v125
  v_exp_f32 v126, v126
  v_exp_f32 v127, v127
  v_cvt_pk_bf16_f32 v138, v124, v125
  v_cvt_pk_bf16_f32 v139, v126, v127
  v_mfma_f32_32x32x16_bf16 v[104:119], v[172:175], v[28:31], v[104:119]
  v_exp_f32 v128, v128
  v_exp_f32 v129, v129
  v_exp_f32 v130, v130
  v_exp_f32 v131, v131
  v_cvt_pk_bf16_f32 v140, v128, v129
  v_cvt_pk_bf16_f32 v141, v130, v131
  v_mfma_f32_32x32x16_bf16 v[56:71], v[200:203], v[136:139], v[56:71]
  v_exp_f32 v132, v132
  v_exp_f32 v133, v133
  v_exp_f32 v134, v134
  v_exp_f32 v135, v135
  v_cvt_pk_bf16_f32 v142, v132, v133
  v_cvt_pk_bf16_f32 v143, v134, v135
  v_mfma_f32_32x32x16_bf16 v[120:135], v[168:171], v[32:35], 0
  v_exp_f32 v104, v104
  v_exp_f32 v105, v105
  v_exp_f32 v106, v106
  v_exp_f32 v107, v107
  v_cvt_pk_bf16_f32 v136, v104, v105
  v_cvt_pk_bf16_f32 v137, v106, v107
  v_mfma_f32_32x32x16_bf16 v[56:71], v[204:207], v[140:143], v[56:71]
  v_exp_f32 v108, v108
  v_exp_f32 v109, v109
  v_exp_f32 v110, v110
  v_exp_f32 v111, v111
  v_cvt_pk_bf16_f32 v138, v108, v109
  v_cvt_pk_bf16_f32 v139, v110, v111
  v_mfma_f32_32x32x16_bf16 v[120:135], v[172:175], v[36:39], v[120:135]
  v_exp_f32 v112, v112
  v_exp_f32 v113, v113
  v_exp_f32 v114, v114
  v_exp_f32 v115, v115
  v_cvt_pk_bf16_f32 v140, v112, v113
  v_cvt_pk_bf16_f32 v141, v114, v115
  v_mfma_f32_32x32x16_bf16 v[72:87], v[200:203], v[136:139], v[72:87]
  buffer_load_dwordx4 v[168:171], v2, s[24:27], s59 offen offset:0 sc1
  v_exp_f32 v116, v116
  v_exp_f32 v117, v117
  v_exp_f32 v118, v118
  v_exp_f32 v119, v119
  v_cvt_pk_bf16_f32 v142, v116, v117
  v_cvt_pk_bf16_f32 v143, v118, v119
  s_waitcnt vmcnt(11)
  v_mfma_f32_32x32x16_bf16 v[104:119], v[144:147], v[8:11], 0
  buffer_load_dwordx4 v[172:175], v2, s[24:27], s59 offen offset:1024 sc1
  v_exp_f32 v120, v120
  v_exp_f32 v121, v121
  v_exp_f32 v122, v122
  v_exp_f32 v123, v123
  v_cvt_pk_bf16_f32 v136, v120, v121
  v_cvt_pk_bf16_f32 v137, v122, v123
  v_mfma_f32_32x32x16_bf16 v[72:87], v[204:207], v[140:143], v[72:87]
  v_exp_f32 v124, v124
  v_exp_f32 v125, v125
  v_exp_f32 v126, v126
  v_exp_f32 v127, v127
  v_cvt_pk_bf16_f32 v138, v124, v125
  v_cvt_pk_bf16_f32 v139, v126, v127
  v_mfma_f32_32x32x16_bf16 v[104:119], v[148:151], v[12:15], v[104:119]
  v_exp_f32 v128, v128
  v_exp_f32 v129, v129
  v_exp_f32 v130, v130
  v_exp_f32 v131, v131
  v_cvt_pk_bf16_f32 v140, v128, v129
  v_cvt_pk_bf16_f32 v141, v130, v131
  v_mfma_f32_32x32x16_bf16 v[88:103], v[200:203], v[136:139], v[88:103]
  v_exp_f32 v132, v132
  v_exp_f32 v133, v133
  v_exp_f32 v134, v134
  v_exp_f32 v135, v135
  v_cvt_pk_bf16_f32 v142, v132, v133
  v_cvt_pk_bf16_f32 v143, v134, v135
  s_waitcnt vmcnt(2)
  v_cmp_ne_u64 vcc, s[40:41], v[208:209]
  v_cmp_ne_u64 s[22:23], s[40:41], v[210:211]
  s_nop 1
  s_or_b64 vcc, vcc, s[22:23]
  v_cmp_ne_u64 s[22:23], s[40:41], v[212:213]
  s_nop 1
  s_or_b64 vcc, vcc, s[22:23]
  v_cmp_ne_u64 s[22:23], s[40:41], v[214:215]
  s_nop 1
  s_or_b64 vcc, vcc, s[22:23]
  s_cbranch_vccz Lrfo_sequential_preLN__mha_block__dense_activation_silu__prompt_kernel_10
  s_mov_b32 s50, 0
Lrf_sequential_preLN__mha_block__dense_activation_silu__prompt_kernel_9:
  buffer_load_dwordx4 v[208:211], v2, s[24:27], s51 offen offset:0 sc1
  buffer_load_dwordx4 v[212:215], v2, s[24:27], s51 offen offset:768 sc1
  s_add_u32 s50, s50, 1
  s_waitcnt vmcnt(0)
  v_cmp_ne_u64 vcc, s[40:41], v[208:209]
  v_cmp_ne_u64 s[22:23], s[40:41], v[210:211]
  s_nop 1
  s_or_b64 vcc, vcc, s[22:23]
  v_cmp_ne_u64 s[22:23], s[40:41], v[212:213]
  s_nop 1
  s_or_b64 vcc, vcc, s[22:23]
  v_cmp_ne_u64 s[22:23], s[40:41], v[214:215]
  s_nop 1
  s_or_b64 vcc, vcc, s[22:23]
  s_cmp_ge_u32 s50, 200000
  s_cbranch_scc1 Lrfo_sequential_preLN__mha_block__dense_activation_silu__prompt_kernel_10
  s_cbranch_vccnz Lrf_sequential_preLN__mha_block__dense_activation_silu__prompt_kernel_9
Lrfo_sequential_preLN__mha_block__dense_activation_silu__prompt_kernel_10:
  v_mfma_f32_32x32x16_bf16 v[120:135], v[144:147], v[16:19], 0
  buffer_load_dwordx4 v2, s[32:35], s72 offen offset:0 sc1 lds
  v_exp_f32 v104, v104
  v_exp_f32 v105, v105
  v_exp_f32 v106, v106
  v_exp_f32 v107, v107
  v_cvt_pk_bf16_f32 v136, v104, v105
  v_cvt_pk_bf16_f32 v137, v106, v107
  v_mfma_f32_32x32x16_bf16 v[88:103], v[204:207], v[140:143], v[88:103]
  buffer_load_dwordx4 v2, s[32:35], s72 offen offset:1024 sc1 lds
  v_exp_f32 v108, v108
  v_exp_f32 v109, v109
  v_exp_f32 v110, v110
  v_exp_f32 v111, v111
  v_cvt_pk_bf16_f32 v138, v108, v109
  v_cvt_pk_bf16_f32 v139, v110, v111
  v_mfma_f32_32x32x16_bf16 v[120:135], v[148:151], v[20:23], v[120:135]
  buffer_load_dwordx4 v[200:203], v2, s[24:27], s59 offen offset:2048 sc1
  v_exp_f32 v112, v112
  v_exp_f32 v113, v113
  v_exp_f32 v114, v114
  v_exp_f32 v115, v115
  v_cvt_pk_bf16_f32 v140, v112, v113
  v_cvt_pk_bf16_f32 v141, v114, v115
  v_mfma_f32_32x32x16_bf16 v[40:55], v[176:179], v[136:139], v[40:55]
  buffer_load_dwordx4 v[204:207], v2, s[24:27], s59 offen offset:3072 sc1
  v_exp_f32 v116, v116
  v_exp_f32 v117, v117
  v_exp_f32 v118, v118
  v_exp_f32 v119, v119
  v_cvt_pk_bf16_f32 v142, v116, v117
  v_cvt_pk_bf16_f32 v143, v118, v119
  v_mfma_f32_32x32x16_bf16 v[104:119], v[144:147], v[24:27], 0
  buffer_load_dwordx4 v2, s[32:35], s72 offen offset:2048 sc1 lds
  v_exp_f32 v120, v120
  v_exp_f32 v121, v121
  v_exp_f32 v122, v122
  v_exp_f32 v123, v123
  v_cvt_pk_bf16_f32 v136, v120, v121
  v_cvt_pk_bf16_f32 v137, v122, v123
  v_mfma_f32_32x32x16_bf16 v[40:55], v[180:183], v[140:143], v[40:55]
  buffer_load_dwordx4 v2, s[32:35], s72 offen offset:3072 sc1 lds
  v_exp_f32 v124, v124
  v_exp_f32 v125, v125
  v_exp_f32 v126, v126
  v_exp_f32 v127, v127
  v_cvt_pk_bf16_f32 v138, v124, v125
  v_cvt_pk_bf16_f32 v139, v126, v127
  v_mfma_f32_32x32x16_bf16 v[104:119], v[148:151], v[28:31], v[104:119]
  s_add_u32 m0, m0, 4096
  v_exp_f32 v128, v128
  v_exp_f32 v129, v129
  v_exp_f32 v130, v130
  v_exp_f32 v131, v131
  v_cvt_pk_bf16_f32 v140, v128, v129
  v_cvt_pk_bf16_f32 v141, v130, v131
  v_mfma_f32_32x32x16_bf16 v[56:71], v[176:179], v[136:139], v[56:71]
  v_exp_f32 v132, v132
  v_exp_f32 v133, v133
  v_exp_f32 v134, v134
  v_exp_f32 v135, v135
  v_cvt_pk_bf16_f32 v142, v132, v133
  v_cvt_pk_bf16_f32 v143, v134, v135
  v_mfma_f32_32x32x16_bf16 v[120:135], v[144:147], v[32:35], 0
  buffer_load_dwordx4 v216, s[32:35], s72 offen offset:0 sc1 lds
  v_exp_f32 v104, v104
  v_exp_f32 v105, v105
  v_exp_f32 v106, v106
  v_exp_f32 v107, v107
  v_cvt_pk_bf16_f32 v136, v104, v105
  v_cvt_pk_bf16_f32 v137, v106, v107
  v_mfma_f32_32x32x16_bf16 v[56:71], v[180:183], v[140:143], v[56:71]
  buffer_load_dwordx4 v216, s[32:35], s72 offen offset:1024 sc1 lds
  v_exp_f32 v108, v108
  v_exp_f32 v109, v109
  v_exp_f32 v110, v110
  v_exp_f32 v111, v111
  v_cvt_pk_bf16_f32 v138, v108, v109
  v_cvt_pk_bf16_f32 v139, v110, v111
  v_mfma_f32_32x32x16_bf16 v[120:135], v[148:151], v[36:39], v[120:135]
  buffer_load_dwordx4 v216, s[32:35], s72 offen offset:2048 sc1 lds
  v_exp_f32 v112, v112
  v_exp_f32 v113, v113
  v_exp_f32 v114, v114
  v_exp_f32 v115, v115
  v_cvt_pk_bf16_f32 v140, v112, v113
  v_cvt_pk_bf16_f32 v141, v114, v115
  v_mfma_f32_32x32x16_bf16 v[72:87], v[176:179], v[136:139], v[72:87]
  buffer_load_dwordx4 v[144:147], v2, s[24:27], s60 offen offset:0 sc1
  v_exp_f32 v116, v116
  v_exp_f32 v117, v117
  v_exp_f32 v118, v118
  v_exp_f32 v119, v119
  v_cvt_pk_bf16_f32 v142, v116, v117
  v_cvt_pk_bf16_f32 v143, v118, v119
  v_mfma_f32_32x32x16_bf16 v[104:119], v[152:155], v[8:11], 0
  buffer_load_dwordx4 v[148:151], v2, s[24:27], s60 offen offset:1024 sc1
  v_exp_f32 v120, v120
  v_exp_f32 v121, v121
  v_exp_f32 v122, v122
  v_exp_f32 v123, v123
  v_cvt_pk_bf16_f32 v136, v120, v121
  v_cvt_pk_bf16_f32 v137, v122, v123
  v_mfma_f32_32x32x16_bf16 v[72:87], v[180:183], v[140:143], v[72:87]
  s_add_u32 m0, m0, 24576
  v_exp_f32 v124, v124
  v_exp_f32 v125, v125
  v_exp_f32 v126, v126
  v_exp_f32 v127, v127
  v_cvt_pk_bf16_f32 v138, v124, v125
  v_cvt_pk_bf16_f32 v139, v126, v127
  v_mfma_f32_32x32x16_bf16 v[104:119], v[156:159], v[12:15], v[104:119]
  buffer_load_dwordx4 v2, s[32:35], s10 offen offset:0 sc1 lds
  v_exp_f32 v128, v128
  v_exp_f32 v129, v129
  v_exp_f32 v130, v130
  v_exp_f32 v131, v131
  v_cvt_pk_bf16_f32 v140, v128, v129
  v_cvt_pk_bf16_f32 v141, v130, v131
  v_mfma_f32_32x32x16_bf16 v[88:103], v[176:179], v[136:139], v[88:103]
  v_exp_f32 v132, v132
  v_exp_f32 v133, v133
  v_exp_f32 v134, v134
  v_exp_f32 v135, v135
  v_cvt_pk_bf16_f32 v142, v132, v133
  v_cvt_pk_bf16_f32 v143, v134, v135
  v_mfma_f32_32x32x16_bf16 v[120:135], v[152:155], v[16:19], 0
  buffer_load_dwordx4 v2, s[32:35], s10 offen offset:1024 sc1 lds
  v_exp_f32 v104, v104
  v_exp_f32 v105, v105
  v_exp_f32 v106, v106
  v_exp_f32 v107, v107
  v_cvt_pk_bf16_f32 v136, v104, v105
  v_cvt_pk_bf16_f32 v137, v106, v107
  v_mfma_f32_32x32x16_bf16 v[88:103], v[180:183], v[140:143], v[88:103]
  buffer_load_dwordx4 v2, s[32:35], s10 offen offset:2048 sc1 lds
  v_exp_f32 v108, v108
  v_exp_f32 v109, v109
  v_exp_f32 v110, v110
  v_exp_f32 v111, v111
  v_cvt_pk_bf16_f32 v138, v108, v109
  v_cvt_pk_bf16_f32 v139, v110, v111
  v_mfma_f32_32x32x16_bf16 v[120:135], v[156:159], v[20:23], v[120:135]
  buffer_load_dwordx4 v[176:179], v2, s[24:27], s60 offen offset:2048 sc1
  v_exp_f32 v112, v112
  v_exp_f32 v113, v113
  v_exp_f32 v114, v114
  v_exp_f32 v115, v115
  v_cvt_pk_bf16_f32 v140, v112, v113
  v_cvt_pk_bf16_f32 v141, v114, v115
  v_mfma_f32_32x32x16_bf16 v[40:55], v[184:187], v[136:139], v[40:55]
  buffer_load_dwordx4 v[180:183], v2, s[24:27], s60 offen offset:3072 sc1
  v_exp_f32 v116, v116
  v_exp_f32 v117, v117
  v_exp_f32 v118, v118
  v_exp_f32 v119, v119
  v_cvt_pk_bf16_f32 v142, v116, v117
  v_cvt_pk_bf16_f32 v143, v118, v119
  v_mfma_f32_32x32x16_bf16 v[104:119], v[152:155], v[24:27], 0
  buffer_load_dwordx4 v2, s[32:35], s10 offen offset:3072 sc1 lds
  v_exp_f32 v120, v120
  v_exp_f32 v121, v121
  v_exp_f32 v122, v122
  v_exp_f32 v123, v123
  v_cvt_pk_bf16_f32 v136, v120, v121
  v_cvt_pk_bf16_f32 v137, v122, v123
  v_mfma_f32_32x32x16_bf16 v[40:55], v[188:191], v[140:143], v[40:55]
  s_add_u32 m0, m0, 4096
  v_exp_f32 v124, v124
  v_exp_f32 v125, v125
  v_exp_f32 v126, v126
  v_exp_f32 v127, v127
  v_cvt_pk_bf16_f32 v138, v124, v125
  v_cvt_pk_bf16_f32 v139, v126, v127
  v_mfma_f32_32x32x16_bf16 v[104:119], v[156:159], v[28:31], v[104:119]
  buffer_load_dwordx4 v216, s[32:35], s10 offen offset:0 sc1 lds
  v_exp_f32 v128, v128
  v_exp_f32 v129, v129
  v_exp_f32 v130, v130
  v_exp_f32 v131, v131
  v_cvt_pk_bf16_f32 v140, v128, v129
  v_cvt_pk_bf16_f32 v141, v130, v131
  v_mfma_f32_32x32x16_bf16 v[56:71], v[184:187], v[136:139], v[56:71]
  v_exp_f32 v132, v132
  v_exp_f32 v133, v133
  v_exp_f32 v134, v134
  v_exp_f32 v135, v135
  v_cvt_pk_bf16_f32 v142, v132, v133
  v_cvt_pk_bf16_f32 v143, v134, v135
  v_mfma_f32_32x32x16_bf16 v[120:135], v[152:155], v[32:35], 0
  buffer_load_dwordx4 v216, s[32:35], s10 offen offset:1024 sc1 lds
  v_exp_f32 v104, v104
  v_exp_f32 v105, v105
  v_exp_f32 v106, v106
  v_exp_f32 v107, v107
  v_cvt_pk_bf16_f32 v136, v104, v105
  v_cvt_pk_bf16_f32 v137, v106, v107
  v_mfma_f32_32x32x16_bf16 v[56:71], v[188:191], v[140:143], v[56:71]
  buffer_load_dwordx4 v216, s[32:35], s10 offen offset:2048 sc1 lds
  v_exp_f32 v108, v108
  v_exp_f32 v109, v109
  v_exp_f32 v110, v110
  v_exp_f32 v111, v111
  v_cvt_pk_bf16_f32 v138, v108, v109
  v_cvt_pk_bf16_f32 v139, v110, v111
  v_mfma_f32_32x32x16_bf16 v[120:135], v[156:159], v[36:39], v[120:135]
  s_add_u32 m0, m0, 24576
  v_exp_f32 v112, v112
  v_exp_f32 v113, v113
  v_exp_f32 v114, v114
  v_exp_f32 v115, v115
  v_cvt_pk_bf16_f32 v140, v112, v113
  v_cvt_pk_bf16_f32 v141, v114, v115
  v_mfma_f32_32x32x16_bf16 v[72:87], v[184:187], v[136:139], v[72:87]
  buffer_load_dwordx4 v[152:155], v2, s[24:27], s61 offen offset:0 sc1
  v_exp_f32 v116, v116
  v_exp_f32 v117, v117
  v_exp_f32 v118, v118
  v_exp_f32 v119, v119
  v_cvt_pk_bf16_f32 v142, v116, v117
  v_cvt_pk_bf16_f32 v143, v118, v119
  v_mfma_f32_32x32x16_bf16 v[104:119], v[160:163], v[8:11], 0
  buffer_load_dwordx4 v[156:159], v2, s[24:27], s61 offen offset:1024 sc1
  v_exp_f32 v120, v120
  v_exp_f32 v121, v121
  v_exp_f32 v122, v122
  v_exp_f32 v123, v123
  v_cvt_pk_bf16_f32 v136, v120, v121
  v_cvt_pk_bf16_f32 v137, v122, v123
  v_mfma_f32_32x32x16_bf16 v[72:87], v[188:191], v[140:143], v[72:87]
  buffer_load_dwordx4 v2, s[32:35], s74 offen offset:0 sc1 lds
  v_exp_f32 v124, v124
  v_exp_f32 v125, v125
  v_exp_f32 v126, v126
  v_exp_f32 v127, v127
  v_cvt_pk_bf16_f32 v138, v124, v125
  v_cvt_pk_bf16_f32 v139, v126, v127
  v_mfma_f32_32x32x16_bf16 v[104:119], v[164:167], v[12:15], v[104:119]
  buffer_load_dwordx4 v2, s[32:35], s74 offen offset:1024 sc1 lds
  v_exp_f32 v128, v128
  v_exp_f32 v129, v129
  v_exp_f32 v130, v130
  v_exp_f32 v131, v131
  v_cvt_pk_bf16_f32 v140, v128, v129
  v_cvt_pk_bf16_f32 v141, v130, v131
  v_mfma_f32_32x32x16_bf16 v[88:103], v[184:187], v[136:139], v[88:103]
  v_exp_f32 v132, v132
  v_exp_f32 v133, v133
  v_exp_f32 v134, v134
  v_exp_f32 v135, v135
  v_cvt_pk_bf16_f32 v142, v132, v133
  v_cvt_pk_bf16_f32 v143, v134, v135
  v_mfma_f32_32x32x16_bf16 v[120:135], v[160:163], v[16:19], 0
  buffer_load_dwordx4 v2, s[32:35], s74 offen offset:2048 sc1 lds
  v_exp_f32 v104, v104
  v_exp_f32 v105, v105
  v_exp_f32 v106, v106
  v_exp_f32 v107, v107
  v_cvt_pk_bf16_f32 v136, v104, v105
  v_cvt_pk_bf16_f32 v137, v106, v107
  v_mfma_f32_32x32x16_bf16 v[88:103], v[188:191], v[140:143], v[88:103]
  buffer_load_dwordx4 v2, s[32:35], s74 offen offset:3072 sc1 lds
  v_exp_f32 v108, v108
  v_exp_f32 v109, v109
  v_exp_f32 v110, v110
  v_exp_f32 v111, v111
  v_cvt_pk_bf16_f32 v138, v108, v109
  v_cvt_pk_bf16_f32 v139, v110, v111
  v_mfma_f32_32x32x16_bf16 v[120:135], v[164:167], v[20:23], v[120:135]
  buffer_load_dwordx4 v[184:187], v2, s[24:27], s61 offen offset:2048 sc1
  v_exp_f32 v112, v112
  v_exp_f32 v113, v113
  v_exp_f32 v114, v114
  v_exp_f32 v115, v115
  v_cvt_pk_bf16_f32 v140, v112, v113
  v_cvt_pk_bf16_f32 v141, v114, v115
  v_mfma_f32_32x32x16_bf16 v[40:55], v[192:195], v[136:139], v[40:55]
  buffer_load_dwordx4 v[188:191], v2, s[24:27], s61 offen offset:3072 sc1
  v_exp_f32 v116, v116
  v_exp_f32 v117, v117
  v_exp_f32 v118, v118
  v_exp_f32 v119, v119
  v_cvt_pk_bf16_f32 v142, v116, v117
  v_cvt_pk_bf16_f32 v143, v118, v119
  v_mfma_f32_32x32x16_bf16 v[104:119], v[160:163], v[24:27], 0
  s_add_u32 m0, m0, 4096
  v_exp_f32 v120, v120
  v_exp_f32 v121, v121
  v_exp_f32 v122, v122
  v_exp_f32 v123, v123
  v_cvt_pk_bf16_f32 v136, v120, v121
  v_cvt_pk_bf16_f32 v137, v122, v123
  v_mfma_f32_32x32x16_bf16 v[40:55], v[196:199], v[140:143], v[40:55]
  buffer_load_dwordx4 v216, s[32:35], s74 offen offset:0 sc1 lds
  v_exp_f32 v124, v124
  v_exp_f32 v125, v125
  v_exp_f32 v126, v126
  v_exp_f32 v127, v127
  v_cvt_pk_bf16_f32 v138, v124, v125
  v_cvt_pk_bf16_f32 v139, v126, v127
  v_mfma_f32_32x32x16_bf16 v[104:119], v[164:167], v[28:31], v[104:119]
  buffer_load_dwordx4 v216, s[32:35], s74 offen offset:1024 sc1 lds
  v_exp_f32 v128, v128
  v_exp_f32 v129, v129
  v_exp_f32 v130, v130
  v_exp_f32 v131, v131
  v_cvt_pk_bf16_f32 v140, v128, v129
  v_cvt_pk_bf16_f32 v141, v130, v131
  v_mfma_f32_32x32x16_bf16 v[56:71], v[192:195], v[136:139], v[56:71]
  v_exp_f32 v132, v132
  v_exp_f32 v133, v133
  v_exp_f32 v134, v134
  v_exp_f32 v135, v135
  v_cvt_pk_bf16_f32 v142, v132, v133
  v_cvt_pk_bf16_f32 v143, v134, v135
  v_mfma_f32_32x32x16_bf16 v[120:135], v[160:163], v[32:35], 0
  buffer_load_dwordx4 v216, s[32:35], s74 offen offset:2048 sc1 lds
  v_exp_f32 v104, v104
  v_exp_f32 v105, v105
  v_exp_f32 v106, v106
  v_exp_f32 v107, v107
  v_cvt_pk_bf16_f32 v136, v104, v105
  v_cvt_pk_bf16_f32 v137, v106, v107
  v_mfma_f32_32x32x16_bf16 v[56:71], v[196:199], v[140:143], v[56:71]
  s_add_u32 m0, m0, 24576
  v_exp_f32 v108, v108
  v_exp_f32 v109, v109
  v_exp_f32 v110, v110
  v_exp_f32 v111, v111
  v_cvt_pk_bf16_f32 v138, v108, v109
  v_cvt_pk_bf16_f32 v139, v110, v111
  v_mfma_f32_32x32x16_bf16 v[120:135], v[164:167], v[36:39], v[120:135]
  buffer_load_dwordx4 v2, s[32:35], s75 offen offset:0 sc1 lds
  v_exp_f32 v112, v112
  v_exp_f32 v113, v113
  v_exp_f32 v114, v114
  v_exp_f32 v115, v115
  v_cvt_pk_bf16_f32 v140, v112, v113
  v_cvt_pk_bf16_f32 v141, v114, v115
  v_mfma_f32_32x32x16_bf16 v[72:87], v[192:195], v[136:139], v[72:87]
  buffer_load_dwordx4 v[160:163], v2, s[24:27], s62 offen offset:0 sc1
  v_exp_f32 v116, v116
  v_exp_f32 v117, v117
  v_exp_f32 v118, v118
  v_exp_f32 v119, v119
  v_cvt_pk_bf16_f32 v142, v116, v117
  v_cvt_pk_bf16_f32 v143, v118, v119
  s_waitcnt vmcnt(29)
  v_mfma_f32_32x32x16_bf16 v[104:119], v[168:171], v[8:11], 0
  buffer_load_dwordx4 v[164:167], v2, s[24:27], s62 offen offset:1024 sc1
  v_exp_f32 v120, v120
  v_exp_f32 v121, v121
  v_exp_f32 v122, v122
  v_exp_f32 v123, v123
  v_cvt_pk_bf16_f32 v136, v120, v121
  v_cvt_pk_bf16_f32 v137, v122, v123
  v_mfma_f32_32x32x16_bf16 v[72:87], v[196:199], v[140:143], v[72:87]
  buffer_load_dwordx4 v2, s[32:35], s75 offen offset:1024 sc1 lds
  v_exp_f32 v124, v124
  v_exp_f32 v125, v125
  v_exp_f32 v126, v126
  v_exp_f32 v127, v127
  v_cvt_pk_bf16_f32 v138, v124, v125
  v_cvt_pk_bf16_f32 v139, v126, v127
  v_mfma_f32_32x32x16_bf16 v[104:119], v[172:175], v[12:15], v[104:119]
  buffer_load_dwordx4 v2, s[32:35], s75 offen offset:2048 sc1 lds
  v_exp_f32 v128, v128
  v_exp_f32 v129, v129
  v_exp_f32 v130, v130
  v_exp_f32 v131, v131
  v_cvt_pk_bf16_f32 v140, v128, v129
  v_cvt_pk_bf16_f32 v141, v130, v131
  v_mfma_f32_32x32x16_bf16 v[88:103], v[192:195], v[136:139], v[88:103]
  v_exp_f32 v132, v132
  v_exp_f32 v133, v133
  v_exp_f32 v134, v134
  v_exp_f32 v135, v135
  v_cvt_pk_bf16_f32 v142, v132, v133
  v_cvt_pk_bf16_f32 v143, v134, v135
  v_mfma_f32_32x32x16_bf16 v[120:135], v[168:171], v[16:19], 0
  buffer_load_dwordx4 v2, s[32:35], s75 offen offset:3072 sc1 lds
  v_exp_f32 v104, v104
  v_exp_f32 v105, v105
  v_exp_f32 v106, v106
  v_exp_f32 v107, v107
  v_cvt_pk_bf16_f32 v136, v104, v105
  v_cvt_pk_bf16_f32 v137, v106, v107
  v_mfma_f32_32x32x16_bf16 v[88:103], v[196:199], v[140:143], v[88:103]
  s_add_u32 m0, m0, 4096
  v_exp_f32 v108, v108
  v_exp_f32 v109, v109
  v_exp_f32 v110, v110
  v_exp_f32 v111, v111
  v_cvt_pk_bf16_f32 v138, v108, v109
  v_cvt_pk_bf16_f32 v139, v110, v111
  v_mfma_f32_32x32x16_bf16 v[120:135], v[172:175], v[20:23], v[120:135]
  buffer_load_dwordx4 v[192:195], v2, s[24:27], s62 offen offset:2048 sc1
  v_exp_f32 v112, v112
  v_exp_f32 v113, v113
  v_exp_f32 v114, v114
  v_exp_f32 v115, v115
  v_cvt_pk_bf16_f32 v140, v112, v113
  v_cvt_pk_bf16_f32 v141, v114, v115
  v_mfma_f32_32x32x16_bf16 v[40:55], v[200:203], v[136:139], v[40:55]
  buffer_load_dwordx4 v[196:199], v2, s[24:27], s62 offen offset:3072 sc1
  v_exp_f32 v116, v116
  v_exp_f32 v117, v117
  v_exp_f32 v118, v118
  v_exp_f32 v119, v119
  v_cvt_pk_bf16_f32 v142, v116, v117
  v_cvt_pk_bf16_f32 v143, v118, v119
  v_mfma_f32_32x32x16_bf16 v[104:119], v[168:171], v[24:27], 0
  buffer_load_dwordx4 v216, s[32:35], s75 offen offset:0 sc1 lds
  v_exp_f32 v120, v120
  v_exp_f32 v121, v121
  v_exp_f32 v122, v122
  v_exp_f32 v123, v123
  v_cvt_pk_bf16_f32 v136, v120, v121
  v_cvt_pk_bf16_f32 v137, v122, v123
  v_mfma_f32_32x32x16_bf16 v[40:55], v[204:207], v[140:143], v[40:55]
  buffer_load_dwordx4 v216, s[32:35], s75 offen offset:1024 sc1 lds
  v_exp_f32 v124, v124
  v_exp_f32 v125, v125
  v_exp_f32 v126, v126
  v_exp_f32 v127, v127
  v_cvt_pk_bf16_f32 v138, v124, v125
  v_cvt_pk_bf16_f32 v139, v126, v127
  v_mfma_f32_32x32x16_bf16 v[104:119], v[172:175], v[28:31], v[104:119]
  buffer_load_dwordx4 v216, s[32:35], s75 offen offset:2048 sc1 lds
  v_exp_f32 v128, v128
  v_exp_f32 v129, v129
  v_exp_f32 v130, v130
  v_exp_f32 v131, v131
  v_cvt_pk_bf16_f32 v140, v128, v129
  v_cvt_pk_bf16_f32 v141, v130, v131
  v_mfma_f32_32x32x16_bf16 v[56:71], v[200:203], v[136:139], v[56:71]
  v_exp_f32 v132, v132
  v_exp_f32 v133, v133
  v_exp_f32 v134, v134
  v_exp_f32 v135, v135
  v_cvt_pk_bf16_f32 v142, v132, v133
  v_cvt_pk_bf16_f32 v143, v134, v135
  v_mfma_f32_32x32x16_bf16 v[120:135], v[168:171], v[32:35], 0
  buffer_load_dwordx4 a[224:227], v2, s[32:35], s68 offen offset:0 sc1
  v_exp_f32 v104, v104
  v_exp_f32 v105, v105
  v_exp_f32 v106, v106
  v_exp_f32 v107, v107
  v_cvt_pk_bf16_f32 v136, v104, v105
  v_cvt_pk_bf16_f32 v137, v106, v107
  v_mfma_f32_32x32x16_bf16 v[56:71], v[204:207], v[140:143], v[56:71]
  buffer_load_dwordx4 a[228:231], v2, s[32:35], s68 offen offset:1024 sc1
  v_exp_f32 v108, v108
  v_exp_f32 v109, v109
  v_exp_f32 v110, v110
  v_exp_f32 v111, v111
  v_cvt_pk_bf16_f32 v138, v108, v109
  v_cvt_pk_bf16_f32 v139, v110, v111
  v_mfma_f32_32x32x16_bf16 v[120:135], v[172:175], v[36:39], v[120:135]
  buffer_load_dwordx4 a[232:235], v2, s[32:35], s68 offen offset:2048 sc1
  v_exp_f32 v112, v112
  v_exp_f32 v113, v113
  v_exp_f32 v114, v114
  v_exp_f32 v115, v115
  v_cvt_pk_bf16_f32 v140, v112, v113
  v_cvt_pk_bf16_f32 v141, v114, v115
  v_mfma_f32_32x32x16_bf16 v[72:87], v[200:203], v[136:139], v[72:87]
  buffer_load_dwordx4 v[168:171], v2, s[24:27], s63 offen offset:0 sc1
  v_exp_f32 v116, v116
  v_exp_f32 v117, v117
  v_exp_f32 v118, v118
  v_exp_f32 v119, v119
  v_cvt_pk_bf16_f32 v142, v116, v117
  v_cvt_pk_bf16_f32 v143, v118, v119
  s_waitcnt vmcnt(30)
  v_mfma_f32_32x32x16_bf16 v[104:119], v[144:147], v[8:11], 0
  buffer_load_dwordx4 v[172:175], v2, s[24:27], s63 offen offset:1024 sc1
  v_exp_f32 v120, v120
  v_exp_f32 v121, v121
  v_exp_f32 v122, v122
  v_exp_f32 v123, v123
  v_cvt_pk_bf16_f32 v136, v120, v121
  v_cvt_pk_bf16_f32 v137, v122, v123
  v_mfma_f32_32x32x16_bf16 v[72:87], v[204:207], v[140:143], v[72:87]
  buffer_load_dwordx4 a[236:239], v2, s[32:35], s68 offen offset:3072 sc1
  v_exp_f32 v124, v124
  v_exp_f32 v125, v125
  v_exp_f32 v126, v126
  v_exp_f32 v127, v127
  v_cvt_pk_bf16_f32 v138, v124, v125
  v_cvt_pk_bf16_f32 v139, v126, v127
  v_mfma_f32_32x32x16_bf16 v[104:119], v[148:151], v[12:15], v[104:119]
  buffer_load_dwordx4 a[240:243], v216, s[32:35], s68 offen offset:0 sc1
  v_exp_f32 v128, v128
  v_exp_f32 v129, v129
  v_exp_f32 v130, v130
  v_exp_f32 v131, v131
  v_cvt_pk_bf16_f32 v140, v128, v129
  v_cvt_pk_bf16_f32 v141, v130, v131
  v_mfma_f32_32x32x16_bf16 v[88:103], v[200:203], v[136:139], v[88:103]
  v_exp_f32 v132, v132
  v_exp_f32 v133, v133
  v_exp_f32 v134, v134
  v_exp_f32 v135, v135
  v_cvt_pk_bf16_f32 v142, v132, v133
  v_cvt_pk_bf16_f32 v143, v134, v135
  v_mfma_f32_32x32x16_bf16 v[120:135], v[144:147], v[16:19], 0
  buffer_load_dwordx4 a[244:247], v216, s[32:35], s68 offen offset:1024 sc1
  v_exp_f32 v104, v104
  v_exp_f32 v105, v105
  v_exp_f32 v106, v106
  v_exp_f32 v107, v107
  v_cvt_pk_bf16_f32 v136, v104, v105
  v_cvt_pk_bf16_f32 v137, v106, v107
  v_mfma_f32_32x32x16_bf16 v[88:103], v[204:207], v[140:143], v[88:103]
  buffer_load_dwordx4 a[248:251], v216, s[32:35], s68 offen offset:2048 sc1
  v_exp_f32 v108, v108
  v_exp_f32 v109, v109
  v_exp_f32 v110, v110
  v_exp_f32 v111, v111
  v_cvt_pk_bf16_f32 v138, v108, v109
  v_cvt_pk_bf16_f32 v139, v110, v111
  v_mfma_f32_32x32x16_bf16 v[120:135], v[148:151], v[20:23], v[120:135]
  buffer_load_dwordx4 v[200:203], v2, s[24:27], s63 offen offset:2048 sc1
  v_exp_f32 v112, v112
  v_exp_f32 v113, v113
  v_exp_f32 v114, v114
  v_exp_f32 v115, v115
  v_cvt_pk_bf16_f32 v140, v112, v113
  v_cvt_pk_bf16_f32 v141, v114, v115
  v_mfma_f32_32x32x16_bf16 v[40:55], v[176:179], v[136:139], v[40:55]
  buffer_load_dwordx4 v[204:207], v2, s[24:27], s63 offen offset:3072 sc1
  v_exp_f32 v116, v116
  v_exp_f32 v117, v117
  v_exp_f32 v118, v118
  v_exp_f32 v119, v119
  v_cvt_pk_bf16_f32 v142, v116, v117
  v_cvt_pk_bf16_f32 v143, v118, v119
  v_mfma_f32_32x32x16_bf16 v[104:119], v[144:147], v[24:27], 0
  buffer_load_dwordx4 a[252:255], v216, s[32:35], s68 offen offset:3072 sc1
  v_exp_f32 v120, v120
  v_exp_f32 v121, v121
  v_exp_f32 v122, v122
  v_exp_f32 v123, v123
  v_cvt_pk_bf16_f32 v136, v120, v121
  v_cvt_pk_bf16_f32 v137, v122, v123
  v_mfma_f32_32x32x16_bf16 v[40:55], v[180:183], v[140:143], v[40:55]
  buffer_load_dwordx4 v[224:227], v2, s[32:35], s69 offen offset:0 sc1
  v_exp_f32 v124, v124
  v_exp_f32 v125, v125
  v_exp_f32 v126, v126
  v_exp_f32 v127, v127
  v_cvt_pk_bf16_f32 v138, v124, v125
  v_cvt_pk_bf16_f32 v139, v126, v127
  v_mfma_f32_32x32x16_bf16 v[104:119], v[148:151], v[28:31], v[104:119]
  buffer_load_dwordx4 v[228:231], v2, s[32:35], s69 offen offset:1024 sc1
  v_exp_f32 v128, v128
  v_exp_f32 v129, v129
  v_exp_f32 v130, v130
  v_exp_f32 v131, v131
  v_cvt_pk_bf16_f32 v140, v128, v129
  v_cvt_pk_bf16_f32 v141, v130, v131
  v_mfma_f32_32x32x16_bf16 v[56:71], v[176:179], v[136:139], v[56:71]
  v_exp_f32 v132, v132
  v_exp_f32 v133, v133
  v_exp_f32 v134, v134
  v_exp_f32 v135, v135
  v_cvt_pk_bf16_f32 v142, v132, v133
  v_cvt_pk_bf16_f32 v143, v134, v135
  v_mfma_f32_32x32x16_bf16 v[120:135], v[144:147], v[32:35], 0
  buffer_load_dwordx4 v[232:235], v2, s[32:35], s69 offen offset:2048 sc1
  v_exp_f32 v104, v104
  v_exp_f32 v105, v105
  v_exp_f32 v106, v106
  v_exp_f32 v107, v107
  v_cvt_pk_bf16_f32 v136, v104, v105
  v_cvt_pk_bf16_f32 v137, v106, v107
  v_mfma_f32_32x32x16_bf16 v[56:71], v[180:183], v[140:143], v[56:71]
  buffer_load_dwordx4 v[236:239], v2, s[32:35], s69 offen offset:3072 sc1
  v_exp_f32 v108, v108
  v_exp_f32 v109, v109
  v_exp_f32 v110, v110
  v_exp_f32 v111, v111
  v_cvt_pk_bf16_f32 v138, v108, v109
  v_cvt_pk_bf16_f32 v139, v110, v111
  v_mfma_f32_32x32x16_bf16 v[120:135], v[148:151], v[36:39], v[120:135]
  buffer_load_dwordx4 v[240:243], v216, s[32:35], s69 offen offset:0 sc1
  v_exp_f32 v112, v112
  v_exp_f32 v113, v113
  v_exp_f32 v114, v114
  v_exp_f32 v115, v115
  v_cvt_pk_bf16_f32 v140, v112, v113
  v_cvt_pk_bf16_f32 v141, v114, v115
  v_mfma_f32_32x32x16_bf16 v[72:87], v[176:179], v[136:139], v[72:87]
  buffer_load_dwordx4 v[144:147], v2, s[24:27], s64 offen offset:0 sc1
  v_exp_f32 v116, v116
  v_exp_f32 v117, v117
  v_exp_f32 v118, v118
  v_exp_f32 v119, v119
  v_cvt_pk_bf16_f32 v142, v116, v117
  v_cvt_pk_bf16_f32 v143, v118, v119
  s_waitcnt vmcnt(32)
  v_mfma_f32_32x32x16_bf16 v[104:119], v[152:155], v[8:11], 0
  buffer_load_dwordx4 v[148:151], v2, s[24:27], s64 offen offset:1024 sc1
  v_exp_f32 v120, v120
  v_exp_f32 v121, v121
  v_exp_f32 v122, v122
  v_exp_f32 v123, v123
  v_cvt_pk_bf16_f32 v136, v120, v121
  v_cvt_pk_bf16_f32 v137, v122, v123
  v_mfma_f32_32x32x16_bf16 v[72:87], v[180:183], v[140:143], v[72:87]
  buffer_load_dwordx4 v[244:247], v216, s[32:35], s69 offen offset:1024 sc1
  v_exp_f32 v124, v124
  v_exp_f32 v125, v125
  v_exp_f32 v126, v126
  v_exp_f32 v127, v127
  v_cvt_pk_bf16_f32 v138, v124, v125
  v_cvt_pk_bf16_f32 v139, v126, v127
  v_mfma_f32_32x32x16_bf16 v[104:119], v[156:159], v[12:15], v[104:119]
  buffer_load_dwordx4 v[248:251], v216, s[32:35], s69 offen offset:2048 sc1
  v_exp_f32 v128, v128
  v_exp_f32 v129, v129
  v_exp_f32 v130, v130
  v_exp_f32 v131, v131
  v_cvt_pk_bf16_f32 v140, v128, v129
  v_cvt_pk_bf16_f32 v141, v130, v131
  v_mfma_f32_32x32x16_bf16 v[88:103], v[176:179], v[136:139], v[88:103]
  v_exp_f32 v132, v132
  v_exp_f32 v133, v133
  v_exp_f32 v134, v134
  v_exp_f32 v135, v135
  v_cvt_pk_bf16_f32 v142, v132, v133
  v_cvt_pk_bf16_f32 v143, v134, v135
  v_mfma_f32_32x32x16_bf16 v[120:135], v[152:155], v[16:19], 0
  buffer_load_dwordx4 v[252:255], v216, s[32:35], s69 offen offset:3072 sc1
  v_exp_f32 v104, v104
  v_exp_f32 v105, v105
  v_exp_f32 v106, v106
  v_exp_f32 v107, v107
  v_cvt_pk_bf16_f32 v136, v104, v105
  v_cvt_pk_bf16_f32 v137, v106, v107
  v_mfma_f32_32x32x16_bf16 v[88:103], v[180:183], v[140:143], v[88:103]
  buffer_load_dwordx4 a[0:3], v2, s[32:35], s70 offen offset:0 sc1
  v_exp_f32 v108, v108
  v_exp_f32 v109, v109
  v_exp_f32 v110, v110
  v_exp_f32 v111, v111
  v_cvt_pk_bf16_f32 v138, v108, v109
  v_cvt_pk_bf16_f32 v139, v110, v111
  v_mfma_f32_32x32x16_bf16 v[120:135], v[156:159], v[20:23], v[120:135]
  buffer_load_dwordx4 v[176:179], v2, s[24:27], s64 offen offset:2048 sc1
  v_exp_f32 v112, v112
  v_exp_f32 v113, v113
  v_exp_f32 v114, v114
  v_exp_f32 v115, v115
  v_cvt_pk_bf16_f32 v140, v112, v113
  v_cvt_pk_bf16_f32 v141, v114, v115
  v_mfma_f32_32x32x16_bf16 v[40:55], v[184:187], v[136:139], v[40:55]
  buffer_load_dwordx4 v[180:183], v2, s[24:27], s64 offen offset:3072 sc1
  v_exp_f32 v116, v116
  v_exp_f32 v117, v117
  v_exp_f32 v118, v118
  v_exp_f32 v119, v119
  v_cvt_pk_bf16_f32 v142, v116, v117
  v_cvt_pk_bf16_f32 v143, v118, v119
  v_mfma_f32_32x32x16_bf16 v[104:119], v[152:155], v[24:27], 0
  buffer_load_dwordx4 a[112:115], v2, s[32:35], s71 offen offset:0 sc1
  v_exp_f32 v120, v120
  v_exp_f32 v121, v121
  v_exp_f32 v122, v122
  v_exp_f32 v123, v123
  v_cvt_pk_bf16_f32 v136, v120, v121
  v_cvt_pk_bf16_f32 v137, v122, v123
  v_mfma_f32_32x32x16_bf16 v[40:55], v[188:191], v[140:143], v[40:55]
  buffer_load_dwordx4 a[4:7], v217, s[32:35], s70 offen offset:0 sc1
  v_exp_f32 v124, v124
  v_exp_f32 v125, v125
  v_exp_f32 v126, v126
  v_exp_f32 v127, v127
  v_cvt_pk_bf16_f32 v138, v124, v125
  v_cvt_pk_bf16_f32 v139, v126, v127
  v_mfma_f32_32x32x16_bf16 v[104:119], v[156:159], v[28:31], v[104:119]
  buffer_load_dwordx4 a[116:119], v217, s[32:35], s71 offen offset:0 sc1
  v_exp_f32 v128, v128
  v_exp_f32 v129, v129
  v_exp_f32 v130, v130
  v_exp_f32 v131, v131
  v_cvt_pk_bf16_f32 v140, v128, v129
  v_cvt_pk_bf16_f32 v141, v130, v131
  v_mfma_f32_32x32x16_bf16 v[56:71], v[184:187], v[136:139], v[56:71]
  v_exp_f32 v132, v132
  v_exp_f32 v133, v133
  v_exp_f32 v134, v134
  v_exp_f32 v135, v135
  v_cvt_pk_bf16_f32 v142, v132, v133
  v_cvt_pk_bf16_f32 v143, v134, v135
  v_mfma_f32_32x32x16_bf16 v[120:135], v[152:155], v[32:35], 0
  buffer_load_dwordx4 a[8:11], v218, s[32:35], s70 offen offset:0 sc1
  v_exp_f32 v104, v104
  v_exp_f32 v105, v105
  v_exp_f32 v106, v106
  v_exp_f32 v107, v107
  v_cvt_pk_bf16_f32 v136, v104, v105
  v_cvt_pk_bf16_f32 v137, v106, v107
  v_mfma_f32_32x32x16_bf16 v[56:71], v[188:191], v[140:143], v[56:71]
  buffer_load_dwordx4 a[120:123], v218, s[32:35], s71 offen offset:0 sc1
  v_exp_f32 v108, v108
  v_exp_f32 v109, v109
  v_exp_f32 v110, v110
  v_exp_f32 v111, v111
  v_cvt_pk_bf16_f32 v138, v108, v109
  v_cvt_pk_bf16_f32 v139, v110, v111
  v_mfma_f32_32x32x16_bf16 v[120:135], v[156:159], v[36:39], v[120:135]
  buffer_load_dwordx4 a[12:15], v219, s[32:35], s70 offen offset:0 sc1
  v_exp_f32 v112, v112
  v_exp_f32 v113, v113
  v_exp_f32 v114, v114
  v_exp_f32 v115, v115
  v_cvt_pk_bf16_f32 v140, v112, v113
  v_cvt_pk_bf16_f32 v141, v114, v115
  v_mfma_f32_32x32x16_bf16 v[72:87], v[184:187], v[136:139], v[72:87]
  buffer_load_dwordx4 v[152:155], v2, s[24:27], s65 offen offset:0 sc1
  v_exp_f32 v116, v116
  v_exp_f32 v117, v117
  v_exp_f32 v118, v118
  v_exp_f32 v119, v119
  v_cvt_pk_bf16_f32 v142, v116, v117
  v_cvt_pk_bf16_f32 v143, v118, v119
  s_waitcnt vmcnt(35)
  v_mfma_f32_32x32x16_bf16 v[104:119], v[160:163], v[8:11], 0
  buffer_load_dwordx4 v[156:159], v2, s[24:27], s65 offen offset:1024 sc1
  v_exp_f32 v120, v120
  v_exp_f32 v121, v121
  v_exp_f32 v122, v122
  v_exp_f32 v123, v123
  v_cvt_pk_bf16_f32 v136, v120, v121
  v_cvt_pk_bf16_f32 v137, v122, v123
  v_mfma_f32_32x32x16_bf16 v[72:87], v[188:191], v[140:143], v[72:87]
  buffer_load_dwordx4 a[124:127], v219, s[32:35], s71 offen offset:0 sc1
  v_exp_f32 v124, v124
  v_exp_f32 v125, v125
  v_exp_f32 v126, v126
  v_exp_f32 v127, v127
  v_cvt_pk_bf16_f32 v138, v124, v125
  v_cvt_pk_bf16_f32 v139, v126, v127
  v_mfma_f32_32x32x16_bf16 v[104:119], v[164:167], v[12:15], v[104:119]
  buffer_load_dwordx4 a[16:19], v220, s[32:35], s70 offen offset:0 sc1
  v_exp_f32 v128, v128
  v_exp_f32 v129, v129
  v_exp_f32 v130, v130
  v_exp_f32 v131, v131
  v_cvt_pk_bf16_f32 v140, v128, v129
  v_cvt_pk_bf16_f32 v141, v130, v131
  v_mfma_f32_32x32x16_bf16 v[88:103], v[184:187], v[136:139], v[88:103]
  v_exp_f32 v132, v132
  v_exp_f32 v133, v133
  v_exp_f32 v134, v134
  v_exp_f32 v135, v135
  v_cvt_pk_bf16_f32 v142, v132, v133
  v_cvt_pk_bf16_f32 v143, v134, v135
  v_mfma_f32_32x32x16_bf16 v[120:135], v[160:163], v[16:19], 0
  buffer_load_dwordx4 a[128:131], v220, s[32:35], s71 offen offset:0 sc1
  v_exp_f32 v104, v104
  v_exp_f32 v105, v105
  v_exp_f32 v106, v106
  v_exp_f32 v107, v107
  v_cvt_pk_bf16_f32 v136, v104, v105
  v_cvt_pk_bf16_f32 v137, v106, v107
  v_mfma_f32_32x32x16_bf16 v[88:103], v[188:191], v[140:143], v[88:103]
  buffer_load_dwordx4 a[20:23], v221, s[32:35], s70 offen offset:0 sc1
  v_exp_f32 v108, v108
  v_exp_f32 v109, v109
  v_exp_f32 v110, v110
  v_exp_f32 v111, v111
  v_cvt_pk_bf16_f32 v138, v108, v109
  v_cvt_pk_bf16_f32 v139, v110, v111
  v_mfma_f32_32x32x16_bf16 v[120:135], v[164:167], v[20:23], v[120:135]
  buffer_load_dwordx4 v[184:187], v2, s[24:27], s65 offen offset:2048 sc1
  v_exp_f32 v112, v112
  v_exp_f32 v113, v113
  v_exp_f32 v114, v114
  v_exp_f32 v115, v115
  v_cvt_pk_bf16_f32 v140, v112, v113
  v_cvt_pk_bf16_f32 v141, v114, v115
  v_mfma_f32_32x32x16_bf16 v[40:55], v[192:195], v[136:139], v[40:55]
  buffer_load_dwordx4 v[188:191], v2, s[24:27], s65 offen offset:3072 sc1
  v_exp_f32 v116, v116
  v_exp_f32 v117, v117
  v_exp_f32 v118, v118
  v_exp_f32 v119, v119
  v_cvt_pk_bf16_f32 v142, v116, v117
  v_cvt_pk_bf16_f32 v143, v118, v119
  v_mfma_f32_32x32x16_bf16 v[104:119], v[160:163], v[24:27], 0
  buffer_load_dwordx4 a[132:135], v221, s[32:35], s71 offen offset:0 sc1
  v_exp_f32 v120, v120
  v_exp_f32 v121, v121
  v_exp_f32 v122, v122
  v_exp_f32 v123, v123
  v_cvt_pk_bf16_f32 v136, v120, v121
  v_cvt_pk_bf16_f32 v137, v122, v123
  v_mfma_f32_32x32x16_bf16 v[40:55], v[196:199], v[140:143], v[40:55]
  buffer_load_dwordx4 a[24:27], v222, s[32:35], s70 offen offset:0 sc1
  v_exp_f32 v124, v124
  v_exp_f32 v125, v125
  v_exp_f32 v126, v126
  v_exp_f32 v127, v127
  v_cvt_pk_bf16_f32 v138, v124, v125
  v_cvt_pk_bf16_f32 v139, v126, v127
  v_mfma_f32_32x32x16_bf16 v[104:119], v[164:167], v[28:31], v[104:119]
  buffer_load_dwordx4 a[136:139], v222, s[32:35], s71 offen offset:0 sc1
  v_exp_f32 v128, v128
  v_exp_f32 v129, v129
  v_exp_f32 v130, v130
  v_exp_f32 v131, v131
  v_cvt_pk_bf16_f32 v140, v128, v129
  v_cvt_pk_bf16_f32 v141, v130, v131
  v_mfma_f32_32x32x16_bf16 v[56:71], v[192:195], v[136:139], v[56:71]
  v_exp_f32 v132, v132
  v_exp_f32 v133, v133
  v_exp_f32 v134, v134
  v_exp_f32 v135, v135
  v_cvt_pk_bf16_f32 v142, v132, v133
  v_cvt_pk_bf16_f32 v143, v134, v135
  v_mfma_f32_32x32x16_bf16 v[120:135], v[160:163], v[32:35], 0
  buffer_load_dwordx4 a[28:31], v2, s[32:35], s70 offen offset:2048 sc1
  v_exp_f32 v104, v104
  v_exp_f32 v105, v105
  v_exp_f32 v106, v106
  v_exp_f32 v107, v107
  v_cvt_pk_bf16_f32 v136, v104, v105
  v_cvt_pk_bf16_f32 v137, v106, v107
  v_mfma_f32_32x32x16_bf16 v[56:71], v[196:199], v[140:143], v[56:71]
  buffer_load_dwordx4 a[140:143], v2, s[32:35], s71 offen offset:2048 sc1
  v_exp_f32 v108, v108
  v_exp_f32 v109, v109
  v_exp_f32 v110, v110
  v_exp_f32 v111, v111
  v_cvt_pk_bf16_f32 v138, v108, v109
  v_cvt_pk_bf16_f32 v139, v110, v111
  v_mfma_f32_32x32x16_bf16 v[120:135], v[164:167], v[36:39], v[120:135]
  buffer_load_dwordx4 a[32:35], v217, s[32:35], s70 offen offset:2048 sc1
  v_exp_f32 v112, v112
  v_exp_f32 v113, v113
  v_exp_f32 v114, v114
  v_exp_f32 v115, v115
  v_cvt_pk_bf16_f32 v140, v112, v113
  v_cvt_pk_bf16_f32 v141, v114, v115
  v_mfma_f32_32x32x16_bf16 v[72:87], v[192:195], v[136:139], v[72:87]
  buffer_load_dwordx4 v[160:163], v2, s[24:27], s66 offen offset:0 sc1
  v_exp_f32 v116, v116
  v_exp_f32 v117, v117
  v_exp_f32 v118, v118
  v_exp_f32 v119, v119
  v_cvt_pk_bf16_f32 v142, v116, v117
  v_cvt_pk_bf16_f32 v143, v118, v119
  s_waitcnt vmcnt(35)
  v_mfma_f32_32x32x16_bf16 v[104:119], v[168:171], v[8:11], 0
  buffer_load_dwordx4 v[164:167], v2, s[24:27], s66 offen offset:1024 sc1
  v_exp_f32 v120, v120
  v_exp_f32 v121, v121
  v_exp_f32 v122, v122
  v_exp_f32 v123, v123
  v_cvt_pk_bf16_f32 v136, v120, v121
  v_cvt_pk_bf16_f32 v137, v122, v123
  v_mfma_f32_32x32x16_bf16 v[72:87], v[196:199], v[140:143], v[72:87]
  buffer_load_dwordx4 a[144:147], v217, s[32:35], s71 offen offset:2048 sc1
  v_exp_f32 v124, v124
  v_exp_f32 v125, v125
  v_exp_f32 v126, v126
  v_exp_f32 v127, v127
  v_cvt_pk_bf16_f32 v138, v124, v125
  v_cvt_pk_bf16_f32 v139, v126, v127
  v_mfma_f32_32x32x16_bf16 v[104:119], v[172:175], v[12:15], v[104:119]
  buffer_load_dwordx4 a[36:39], v218, s[32:35], s70 offen offset:2048 sc1
  v_exp_f32 v128, v128
  v_exp_f32 v129, v129
  v_exp_f32 v130, v130
  v_exp_f32 v131, v131
  v_cvt_pk_bf16_f32 v140, v128, v129
  v_cvt_pk_bf16_f32 v141, v130, v131
  v_mfma_f32_32x32x16_bf16 v[88:103], v[192:195], v[136:139], v[88:103]
  v_exp_f32 v132, v132
  v_exp_f32 v133, v133
  v_exp_f32 v134, v134
  v_exp_f32 v135, v135
  v_cvt_pk_bf16_f32 v142, v132, v133
  v_cvt_pk_bf16_f32 v143, v134, v135
  v_mfma_f32_32x32x16_bf16 v[120:135], v[168:171], v[16:19], 0
  buffer_load_dwordx4 a[148:151], v218, s[32:35], s71 offen offset:2048 sc1
  v_exp_f32 v104, v104
  v_exp_f32 v105, v105
  v_exp_f32 v106, v106
  v_exp_f32 v107, v107
  v_cvt_pk_bf16_f32 v136, v104, v105
  v_cvt_pk_bf16_f32 v137, v106, v107
  v_mfma_f32_32x32x16_bf16 v[88:103], v[196:199], v[140:143], v[88:103]
  buffer_load_dwordx4 a[40:43], v219, s[32:35], s70 offen offset:2048 sc1
  v_exp_f32 v108, v108
  v_exp_f32 v109, v109
  v_exp_f32 v110, v110
  v_exp_f32 v111, v111
  v_cvt_pk_bf16_f32 v138, v108, v109
  v_cvt_pk_bf16_f32 v139, v110, v111
  v_mfma_f32_32x32x16_bf16 v[120:135], v[172:175], v[20:23], v[120:135]
  buffer_load_dwordx4 v[192:195], v2, s[24:27], s66 offen offset:2048 sc1
  v_exp_f32 v112, v112
  v_exp_f32 v113, v113
  v_exp_f32 v114, v114
  v_exp_f32 v115, v115
  v_cvt_pk_bf16_f32 v140, v112, v113
  v_cvt_pk_bf16_f32 v141, v114, v115
  v_mfma_f32_32x32x16_bf16 v[40:55], v[200:203], v[136:139], v[40:55]
  buffer_load_dwordx4 v[196:199], v2, s[24:27], s66 offen offset:3072 sc1
  v_exp_f32 v116, v116
  v_exp_f32 v117, v117
  v_exp_f32 v118, v118
  v_exp_f32 v119, v119
  v_cvt_pk_bf16_f32 v142, v116, v117
  v_cvt_pk_bf16_f32 v143, v118, v119
  v_mfma_f32_32x32x16_bf16 v[104:119], v[168:171], v[24:27], 0
  buffer_load_dwordx4 a[152:155], v219, s[32:35], s71 offen offset:2048 sc1
  v_exp_f32 v120, v120
  v_exp_f32 v121, v121
  v_exp_f32 v122, v122
  v_exp_f32 v123, v123
  v_cvt_pk_bf16_f32 v136, v120, v121
  v_cvt_pk_bf16_f32 v137, v122, v123
  v_mfma_f32_32x32x16_bf16 v[40:55], v[204:207], v[140:143], v[40:55]
  buffer_load_dwordx4 a[44:47], v220, s[32:35], s70 offen offset:2048 sc1
  v_exp_f32 v124, v124
  v_exp_f32 v125, v125
  v_exp_f32 v126, v126
  v_exp_f32 v127, v127
  v_cvt_pk_bf16_f32 v138, v124, v125
  v_cvt_pk_bf16_f32 v139, v126, v127
  v_mfma_f32_32x32x16_bf16 v[104:119], v[172:175], v[28:31], v[104:119]
  buffer_load_dwordx4 a[156:159], v220, s[32:35], s71 offen offset:2048 sc1
  v_exp_f32 v128, v128
  v_exp_f32 v129, v129
  v_exp_f32 v130, v130
  v_exp_f32 v131, v131
  v_cvt_pk_bf16_f32 v140, v128, v129
  v_cvt_pk_bf16_f32 v141, v130, v131
  v_mfma_f32_32x32x16_bf16 v[56:71], v[200:203], v[136:139], v[56:71]
  v_exp_f32 v132, v132
  v_exp_f32 v133, v133
  v_exp_f32 v134, v134
  v_exp_f32 v135, v135
  v_cvt_pk_bf16_f32 v142, v132, v133
  v_cvt_pk_bf16_f32 v143, v134, v135
  v_mfma_f32_32x32x16_bf16 v[120:135], v[168:171], v[32:35], 0
  buffer_load_dwordx4 a[48:51], v221, s[32:35], s70 offen offset:2048 sc1
  v_exp_f32 v104, v104
  v_exp_f32 v105, v105
  v_exp_f32 v106, v106
  v_exp_f32 v107, v107
  v_cvt_pk_bf16_f32 v136, v104, v105
  v_cvt_pk_bf16_f32 v137, v106, v107
  v_mfma_f32_32x32x16_bf16 v[56:71], v[204:207], v[140:143], v[56:71]
  buffer_load_dwordx4 a[160:163], v221, s[32:35], s71 offen offset:2048 sc1
  v_exp_f32 v108, v108
  v_exp_f32 v109, v109
  v_exp_f32 v110, v110
  v_exp_f32 v111, v111
  v_cvt_pk_bf16_f32 v138, v108, v109
  v_cvt_pk_bf16_f32 v139, v110, v111
  v_mfma_f32_32x32x16_bf16 v[120:135], v[172:175], v[36:39], v[120:135]
  buffer_load_dwordx4 a[52:55], v222, s[32:35], s70 offen offset:2048 sc1
  v_exp_f32 v112, v112
  v_exp_f32 v113, v113
  v_exp_f32 v114, v114
  v_exp_f32 v115, v115
  v_cvt_pk_bf16_f32 v140, v112, v113
  v_cvt_pk_bf16_f32 v141, v114, v115
  v_mfma_f32_32x32x16_bf16 v[72:87], v[200:203], v[136:139], v[72:87]
  buffer_load_dwordx4 v[168:171], v2, s[24:27], s67 offen offset:0 sc1
  v_exp_f32 v116, v116
  v_exp_f32 v117, v117
  v_exp_f32 v118, v118
  v_exp_f32 v119, v119
  v_cvt_pk_bf16_f32 v142, v116, v117
  v_cvt_pk_bf16_f32 v143, v118, v119
  s_waitcnt vmcnt(35)
  v_mfma_f32_32x32x16_bf16 v[104:119], v[144:147], v[8:11], 0
  buffer_load_dwordx4 v[172:175], v2, s[24:27], s67 offen offset:1024 sc1
  v_exp_f32 v120, v120
  v_exp_f32 v121, v121
  v_exp_f32 v122, v122
  v_exp_f32 v123, v123
  v_cvt_pk_bf16_f32 v136, v120, v121
  v_cvt_pk_bf16_f32 v137, v122, v123
  v_mfma_f32_32x32x16_bf16 v[72:87], v[204:207], v[140:143], v[72:87]
  buffer_load_dwordx4 a[164:167], v222, s[32:35], s71 offen offset:2048 sc1
  v_exp_f32 v124, v124
  v_exp_f32 v125, v125
  v_exp_f32 v126, v126
  v_exp_f32 v127, v127
  v_cvt_pk_bf16_f32 v138, v124, v125
  v_cvt_pk_bf16_f32 v139, v126, v127
  v_mfma_f32_32x32x16_bf16 v[104:119], v[148:151], v[12:15], v[104:119]
  buffer_load_dwordx4 a[56:59], v2, s[32:35], s8 offen offset:0 sc1
  v_exp_f32 v128, v128
  v_exp_f32 v129, v129
  v_exp_f32 v130, v130
  v_exp_f32 v131, v131
  v_cvt_pk_bf16_f32 v140, v128, v129
  v_cvt_pk_bf16_f32 v141, v130, v131
  v_mfma_f32_32x32x16_bf16 v[88:103], v[200:203], v[136:139], v[88:103]
  v_exp_f32 v132, v132
  v_exp_f32 v133, v133
  v_exp_f32 v134, v134
  v_exp_f32 v135, v135
  v_cvt_pk_bf16_f32 v142, v132, v133
  v_cvt_pk_bf16_f32 v143, v134, v135
  v_mfma_f32_32x32x16_bf16 v[120:135], v[144:147], v[16:19], 0
  buffer_load_dwordx4 a[168:171], v2, s[32:35], s9 offen offset:0 sc1
  v_exp_f32 v104, v104
  v_exp_f32 v105, v105
  v_exp_f32 v106, v106
  v_exp_f32 v107, v107
  v_cvt_pk_bf16_f32 v136, v104, v105
  v_cvt_pk_bf16_f32 v137, v106, v107
  v_mfma_f32_32x32x16_bf16 v[88:103], v[204:207], v[140:143], v[88:103]
  buffer_load_dwordx4 a[60:63], v217, s[32:35], s8 offen offset:0 sc1
  v_exp_f32 v108, v108
  v_exp_f32 v109, v109
  v_exp_f32 v110, v110
  v_exp_f32 v111, v111
  v_cvt_pk_bf16_f32 v138, v108, v109
  v_cvt_pk_bf16_f32 v139, v110, v111
  v_mfma_f32_32x32x16_bf16 v[120:135], v[148:151], v[20:23], v[120:135]
  buffer_load_dwordx4 v[200:203], v2, s[24:27], s67 offen offset:2048 sc1
  v_exp_f32 v112, v112
  v_exp_f32 v113, v113
  v_exp_f32 v114, v114
  v_exp_f32 v115, v115
  v_cvt_pk_bf16_f32 v140, v112, v113
  v_cvt_pk_bf16_f32 v141, v114, v115
  v_mfma_f32_32x32x16_bf16 v[40:55], v[176:179], v[136:139], v[40:55]
  buffer_load_dwordx4 v[204:207], v2, s[24:27], s67 offen offset:3072 sc1
  v_exp_f32 v116, v116
  v_exp_f32 v117, v117
  v_exp_f32 v118, v118
  v_exp_f32 v119, v119
  v_cvt_pk_bf16_f32 v142, v116, v117
  v_cvt_pk_bf16_f32 v143, v118, v119
  v_mfma_f32_32x32x16_bf16 v[104:119], v[144:147], v[24:27], 0
  buffer_load_dwordx4 a[172:175], v217, s[32:35], s9 offen offset:0 sc1
  v_exp_f32 v120, v120
  v_exp_f32 v121, v121
  v_exp_f32 v122, v122
  v_exp_f32 v123, v123
  v_cvt_pk_bf16_f32 v136, v120, v121
  v_cvt_pk_bf16_f32 v137, v122, v123
  v_mfma_f32_32x32x16_bf16 v[40:55], v[180:183], v[140:143], v[40:55]
  buffer_load_dwordx4 a[64:67], v218, s[32:35], s8 offen offset:0 sc1
  v_exp_f32 v124, v124
  v_exp_f32 v125, v125
  v_exp_f32 v126, v126
  v_exp_f32 v127, v127
  v_cvt_pk_bf16_f32 v138, v124, v125
  v_cvt_pk_bf16_f32 v139, v126, v127
  v_mfma_f32_32x32x16_bf16 v[104:119], v[148:151], v[28:31], v[104:119]
  buffer_load_dwordx4 a[176:179], v218, s[32:35], s9 offen offset:0 sc1
  v_exp_f32 v128, v128
  v_exp_f32 v129, v129
  v_exp_f32 v130, v130
  v_exp_f32 v131, v131
  v_cvt_pk_bf16_f32 v140, v128, v129
  v_cvt_pk_bf16_f32 v141, v130, v131
  v_mfma_f32_32x32x16_bf16 v[56:71], v[176:179], v[136:139], v[56:71]
  v_exp_f32 v132, v132
  v_exp_f32 v133, v133
  v_exp_f32 v134, v134
  v_exp_f32 v135, v135
  v_cvt_pk_bf16_f32 v142, v132, v133
  v_cvt_pk_bf16_f32 v143, v134, v135
  v_mfma_f32_32x32x16_bf16 v[120:135], v[144:147], v[32:35], 0
  buffer_load_dwordx4 a[68:71], v219, s[32:35], s8 offen offset:0 sc1
  v_exp_f32 v104, v104
  v_exp_f32 v105, v105
  v_exp_f32 v106, v106
  v_exp_f32 v107, v107
  v_cvt_pk_bf16_f32 v136, v104, v105
  v_cvt_pk_bf16_f32 v137, v106, v107
  v_mfma_f32_32x32x16_bf16 v[56:71], v[180:183], v[140:143], v[56:71]
  buffer_load_dwordx4 a[180:183], v219, s[32:35], s9 offen offset:0 sc1
  v_exp_f32 v108, v108
  v_exp_f32 v109, v109
  v_exp_f32 v110, v110
  v_exp_f32 v111, v111
  v_cvt_pk_bf16_f32 v138, v108, v109
  v_cvt_pk_bf16_f32 v139, v110, v111
  v_mfma_f32_32x32x16_bf16 v[120:135], v[148:151], v[36:39], v[120:135]
  buffer_load_dwordx4 a[72:75], v220, s[32:35], s8 offen offset:0 sc1
  v_exp_f32 v112, v112
  v_exp_f32 v113, v113
  v_exp_f32 v114, v114
  v_exp_f32 v115, v115
  v_cvt_pk_bf16_f32 v140, v112, v113
  v_cvt_pk_bf16_f32 v141, v114, v115
  v_mfma_f32_32x32x16_bf16 v[72:87], v[176:179], v[136:139], v[72:87]
  v_exp_f32 v116, v116
  v_exp_f32 v117, v117
  v_exp_f32 v118, v118
  v_exp_f32 v119, v119
  v_cvt_pk_bf16_f32 v142, v116, v117
  v_cvt_pk_bf16_f32 v143, v118, v119
  s_waitcnt vmcnt(34)
  v_mfma_f32_32x32x16_bf16 v[104:119], v[152:155], v[8:11], 0
  buffer_load_dwordx4 a[184:187], v220, s[32:35], s9 offen offset:0 sc1
  v_exp_f32 v120, v120
  v_exp_f32 v121, v121
  v_exp_f32 v122, v122
  v_exp_f32 v123, v123
  v_cvt_pk_bf16_f32 v136, v120, v121
  v_cvt_pk_bf16_f32 v137, v122, v123
  v_mfma_f32_32x32x16_bf16 v[72:87], v[180:183], v[140:143], v[72:87]
  buffer_load_dwordx4 a[76:79], v221, s[32:35], s8 offen offset:0 sc1
  v_exp_f32 v124, v124
  v_exp_f32 v125, v125
  v_exp_f32 v126, v126
  v_exp_f32 v127, v127
  v_cvt_pk_bf16_f32 v138, v124, v125
  v_cvt_pk_bf16_f32 v139, v126, v127
  v_mfma_f32_32x32x16_bf16 v[104:119], v[156:159], v[12:15], v[104:119]
  buffer_load_dwordx4 a[188:191], v221, s[32:35], s9 offen offset:0 sc1
  v_exp_f32 v128, v128
  v_exp_f32 v129, v129
  v_exp_f32 v130, v130
  v_exp_f32 v131, v131
  v_cvt_pk_bf16_f32 v140, v128, v129
  v_cvt_pk_bf16_f32 v141, v130, v131
  v_mfma_f32_32x32x16_bf16 v[88:103], v[176:179], v[136:139], v[88:103]
  v_exp_f32 v132, v132
  v_exp_f32 v133, v133
  v_exp_f32 v134, v134
  v_exp_f32 v135, v135
  v_cvt_pk_bf16_f32 v142, v132, v133
  v_cvt_pk_bf16_f32 v143, v134, v135
  v_mfma_f32_32x32x16_bf16 v[120:135], v[152:155], v[16:19], 0
  buffer_load_dwordx4 a[80:83], v222, s[32:35], s8 offen offset:0 sc1
  v_exp_f32 v104, v104
  v_exp_f32 v105, v105
  v_exp_f32 v106, v106
  v_exp_f32 v107, v107
  v_cvt_pk_bf16_f32 v136, v104, v105
  v_cvt_pk_bf16_f32 v137, v106, v107
  v_mfma_f32_32x32x16_bf16 v[88:103], v[180:183], v[140:143], v[88:103]
  buffer_load_dwordx4 a[192:195], v222, s[32:35], s9 offen offset:0 sc1
  v_exp_f32 v108, v108
  v_exp_f32 v109, v109
  v_exp_f32 v110, v110
  v_exp_f32 v111, v111
  v_cvt_pk_bf16_f32 v138, v108, v109
  v_cvt_pk_bf16_f32 v139, v110, v111
  v_mfma_f32_32x32x16_bf16 v[120:135], v[156:159], v[20:23], v[120:135]
  buffer_load_dwordx4 a[84:87], v2, s[32:35], s8 offen offset:2048 sc1
  v_exp_f32 v112, v112
  v_exp_f32 v113, v113
  v_exp_f32 v114, v114
  v_exp_f32 v115, v115
  v_cvt_pk_bf16_f32 v140, v112, v113
  v_cvt_pk_bf16_f32 v141, v114, v115
  v_mfma_f32_32x32x16_bf16 v[40:55], v[184:187], v[136:139], v[40:55]
  v_exp_f32 v116, v116
  v_exp_f32 v117, v117
  v_exp_f32 v118, v118
  v_exp_f32 v119, v119
  v_cvt_pk_bf16_f32 v142, v116, v117
  v_cvt_pk_bf16_f32 v143, v118, v119
  v_mfma_f32_32x32x16_bf16 v[104:119], v[152:155], v[24:27], 0
  buffer_load_dwordx4 a[196:199], v2, s[32:35], s9 offen offset:2048 sc1
  v_exp_f32 v120, v120
  v_exp_f32 v121, v121
  v_exp_f32 v122, v122
  v_exp_f32 v123, v123
  v_cvt_pk_bf16_f32 v136, v120, v121
  v_cvt_pk_bf16_f32 v137, v122, v123
  v_mfma_f32_32x32x16_bf16 v[40:55], v[188:191], v[140:143], v[40:55]
  buffer_load_dwordx4 a[88:91], v217, s[32:35], s8 offen offset:2048 sc1
  v_exp_f32 v124, v124
  v_exp_f32 v125, v125
  v_exp_f32 v126, v126
  v_exp_f32 v127, v127
  v_cvt_pk_bf16_f32 v138, v124, v125
  v_cvt_pk_bf16_f32 v139, v126, v127
  v_mfma_f32_32x32x16_bf16 v[104:119], v[156:159], v[28:31], v[104:119]
  buffer_load_dwordx4 a[200:203], v217, s[32:35], s9 offen offset:2048 sc1
  v_exp_f32 v128, v128
  v_exp_f32 v129, v129
  v_exp_f32 v130, v130
  v_exp_f32 v131, v131
  v_cvt_pk_bf16_f32 v140, v128, v129
  v_cvt_pk_bf16_f32 v141, v130, v131
  v_mfma_f32_32x32x16_bf16 v[56:71], v[184:187], v[136:139], v[56:71]
  v_exp_f32 v132, v132
  v_exp_f32 v133, v133
  v_exp_f32 v134, v134
  v_exp_f32 v135, v135
  v_cvt_pk_bf16_f32 v142, v132, v133
  v_cvt_pk_bf16_f32 v143, v134, v135
  v_mfma_f32_32x32x16_bf16 v[120:135], v[152:155], v[32:35], 0
  buffer_load_dwordx4 a[92:95], v218, s[32:35], s8 offen offset:2048 sc1
  v_exp_f32 v104, v104
  v_exp_f32 v105, v105
  v_exp_f32 v106, v106
  v_exp_f32 v107, v107
  v_cvt_pk_bf16_f32 v136, v104, v105
  v_cvt_pk_bf16_f32 v137, v106, v107
  v_mfma_f32_32x32x16_bf16 v[56:71], v[188:191], v[140:143], v[56:71]
  buffer_load_dwordx4 a[204:207], v218, s[32:35], s9 offen offset:2048 sc1
  v_exp_f32 v108, v108
  v_exp_f32 v109, v109
  v_exp_f32 v110, v110
  v_exp_f32 v111, v111
  v_cvt_pk_bf16_f32 v138, v108, v109
  v_cvt_pk_bf16_f32 v139, v110, v111
  v_mfma_f32_32x32x16_bf16 v[120:135], v[156:159], v[36:39], v[120:135]
  buffer_load_dwordx4 a[96:99], v219, s[32:35], s8 offen offset:2048 sc1
  v_exp_f32 v112, v112
  v_exp_f32 v113, v113
  v_exp_f32 v114, v114
  v_exp_f32 v115, v115
  v_cvt_pk_bf16_f32 v140, v112, v113
  v_cvt_pk_bf16_f32 v141, v114, v115
  v_mfma_f32_32x32x16_bf16 v[72:87], v[184:187], v[136:139], v[72:87]
  v_exp_f32 v116, v116
  v_exp_f32 v117, v117
  v_exp_f32 v118, v118
  v_exp_f32 v119, v119
  v_cvt_pk_bf16_f32 v142, v116, v117
  v_cvt_pk_bf16_f32 v143, v118, v119
  s_waitcnt vmcnt(32)
  v_mfma_f32_32x32x16_bf16 v[104:119], v[160:163], v[16:19], 0
  buffer_load_dwordx4 a[208:211], v219, s[32:35], s9 offen offset:2048 sc1
  v_exp_f32 v120, v120
  v_exp_f32 v121, v121
  v_exp_f32 v122, v122
  v_exp_f32 v123, v123
  v_cvt_pk_bf16_f32 v136, v120, v121
  v_cvt_pk_bf16_f32 v137, v122, v123
  v_mfma_f32_32x32x16_bf16 v[72:87], v[188:191], v[140:143], v[72:87]
  v_exp_f32 v124, v124
  v_exp_f32 v125, v125
  v_exp_f32 v126, v126
  v_exp_f32 v127, v127
  v_cvt_pk_bf16_f32 v138, v124, v125
  v_cvt_pk_bf16_f32 v139, v126, v127
  v_mfma_f32_32x32x16_bf16 v[104:119], v[164:167], v[20:23], v[104:119]
  buffer_load_dwordx4 a[100:103], v220, s[32:35], s8 offen offset:2048 sc1
  v_exp_f32 v128, v128
  v_exp_f32 v129, v129
  v_exp_f32 v130, v130
  v_exp_f32 v131, v131
  v_cvt_pk_bf16_f32 v140, v128, v129
  v_cvt_pk_bf16_f32 v141, v130, v131
  v_mfma_f32_32x32x16_bf16 v[88:103], v[184:187], v[136:139], v[88:103]
  v_exp_f32 v132, v132
  v_exp_f32 v133, v133
  v_exp_f32 v134, v134
  v_exp_f32 v135, v135
  v_cvt_pk_bf16_f32 v142, v132, v133
  v_cvt_pk_bf16_f32 v143, v134, v135
  v_mfma_f32_32x32x16_bf16 v[120:135], v[160:163], v[24:27], 0
  buffer_load_dwordx4 a[212:215], v220, s[32:35], s9 offen offset:2048 sc1
  v_exp_f32 v104, v104
  v_exp_f32 v105, v105
  v_exp_f32 v106, v106
  v_exp_f32 v107, v107
  v_cvt_pk_bf16_f32 v136, v104, v105
  v_cvt_pk_bf16_f32 v137, v106, v107
  v_mfma_f32_32x32x16_bf16 v[88:103], v[188:191], v[140:143], v[88:103]
  v_exp_f32 v108, v108
  v_exp_f32 v109, v109
  v_exp_f32 v110, v110
  v_exp_f32 v111, v111
  v_cvt_pk_bf16_f32 v138, v108, v109
  v_cvt_pk_bf16_f32 v139, v110, v111
  v_mfma_f32_32x32x16_bf16 v[120:135], v[164:167], v[28:31], v[120:135]
  buffer_load_dwordx4 a[104:107], v221, s[32:35], s8 offen offset:2048 sc1
  v_exp_f32 v112, v112
  v_exp_f32 v113, v113
  v_exp_f32 v114, v114
  v_exp_f32 v115, v115
  v_cvt_pk_bf16_f32 v140, v112, v113
  v_cvt_pk_bf16_f32 v141, v114, v115
  v_mfma_f32_32x32x16_bf16 v[56:71], v[192:195], v[136:139], v[56:71]
  v_exp_f32 v116, v116
  v_exp_f32 v117, v117
  v_exp_f32 v118, v118
  v_exp_f32 v119, v119
  v_cvt_pk_bf16_f32 v142, v116, v117
  v_cvt_pk_bf16_f32 v143, v118, v119
  v_mfma_f32_32x32x16_bf16 v[104:119], v[160:163], v[32:35], 0
  buffer_load_dwordx4 a[216:219], v221, s[32:35], s9 offen offset:2048 sc1
  v_exp_f32 v120, v120
  v_exp_f32 v121, v121
  v_exp_f32 v122, v122
  v_exp_f32 v123, v123
  v_cvt_pk_bf16_f32 v136, v120, v121
  v_cvt_pk_bf16_f32 v137, v122, v123
  v_mfma_f32_32x32x16_bf16 v[56:71], v[196:199], v[140:143], v[56:71]
  v_exp_f32 v124, v124
  v_exp_f32 v125, v125
  v_exp_f32 v126, v126
  v_exp_f32 v127, v127
  v_cvt_pk_bf16_f32 v138, v124, v125
  v_cvt_pk_bf16_f32 v139, v126, v127
  v_mfma_f32_32x32x16_bf16 v[104:119], v[164:167], v[36:39], v[104:119]
  buffer_load_dwordx4 a[108:111], v222, s[32:35], s8 offen offset:2048 sc1
  v_exp_f32 v128, v128
  v_exp_f32 v129, v129
  v_exp_f32 v130, v130
  v_exp_f32 v131, v131
  v_cvt_pk_bf16_f32 v140, v128, v129
  v_cvt_pk_bf16_f32 v141, v130, v131
  v_mfma_f32_32x32x16_bf16 v[72:87], v[192:195], v[136:139], v[72:87]
  v_exp_f32 v132, v132
  v_exp_f32 v133, v133
  v_exp_f32 v134, v134
  v_exp_f32 v135, v135
  v_cvt_pk_bf16_f32 v142, v132, v133
  v_cvt_pk_bf16_f32 v143, v134, v135
  s_waitcnt vmcnt(24)
  v_mfma_f32_32x32x16_bf16 v[120:135], v[168:171], v[16:19], 0
  buffer_load_dwordx4 a[220:223], v222, s[32:35], s9 offen offset:2048 sc1
  v_exp_f32 v104, v104
  v_exp_f32 v105, v105
  v_exp_f32 v106, v106
  v_exp_f32 v107, v107
  v_cvt_pk_bf16_f32 v136, v104, v105
  v_cvt_pk_bf16_f32 v137, v106, v107
  v_mfma_f32_32x32x16_bf16 v[72:87], v[196:199], v[140:143], v[72:87]
  v_exp_f32 v108, v108
  v_exp_f32 v109, v109
  v_exp_f32 v110, v110
  v_exp_f32 v111, v111
  v_cvt_pk_bf16_f32 v138, v108, v109
  v_cvt_pk_bf16_f32 v139, v110, v111
  v_mfma_f32_32x32x16_bf16 v[120:135], v[172:175], v[20:23], v[120:135]
  buffer_load_dwordx4 v[208:211], v6, s[28:31], s11 offen offset:0
  v_exp_f32 v112, v112
  v_exp_f32 v113, v113
  v_exp_f32 v114, v114
  v_exp_f32 v115, v115
  v_cvt_pk_bf16_f32 v140, v112, v113
  v_cvt_pk_bf16_f32 v141, v114, v115
  v_mfma_f32_32x32x16_bf16 v[88:103], v[192:195], v[136:139], v[88:103]
  v_exp_f32 v116, v116
  v_exp_f32 v117, v117
  v_exp_f32 v118, v118
  v_exp_f32 v119, v119
  v_cvt_pk_bf16_f32 v142, v116, v117
  v_cvt_pk_bf16_f32 v143, v118, v119
  v_mfma_f32_32x32x16_bf16 v[104:119], v[168:171], v[24:27], 0
  buffer_load_dwordx4 v[212:215], v6, s[28:31], s11 offen offset:32
  v_exp_f32 v120, v120
  v_exp_f32 v121, v121
  v_exp_f32 v122, v122
  v_exp_f32 v123, v123
  v_cvt_pk_bf16_f32 v136, v120, v121
  v_cvt_pk_bf16_f32 v137, v122, v123
  v_mfma_f32_32x32x16_bf16 v[88:103], v[196:199], v[140:143], v[88:103]
  v_exp_f32 v124, v124
  v_exp_f32 v125, v125
  v_exp_f32 v126, v126
  v_exp_f32 v127, v127
  v_cvt_pk_bf16_f32 v138, v124, v125
  v_cvt_pk_bf16_f32 v139, v126, v127
  v_mfma_f32_32x32x16_bf16 v[104:119], v[172:175], v[28:31], v[104:119]
  v_exp_f32 v128, v128
  v_exp_f32 v129, v129
  v_exp_f32 v130, v130
  v_exp_f32 v131, v131
  v_cvt_pk_bf16_f32 v140, v128, v129
  v_cvt_pk_bf16_f32 v141, v130, v131
  v_mfma_f32_32x32x16_bf16 v[56:71], v[200:203], v[136:139], v[56:71]
  v_exp_f32 v132, v132
  v_exp_f32 v133, v133
  v_exp_f32 v134, v134
  v_exp_f32 v135, v135
  v_cvt_pk_bf16_f32 v142, v132, v133
  v_cvt_pk_bf16_f32 v143, v134, v135
  v_mfma_f32_32x32x16_bf16 v[120:135], v[168:171], v[32:35], 0
  v_exp_f32 v104, v104
  v_exp_f32 v105, v105
  v_exp_f32 v106, v106
  v_exp_f32 v107, v107
  v_cvt_pk_bf16_f32 v136, v104, v105
  v_cvt_pk_bf16_f32 v137, v106, v107
  v_mfma_f32_32x32x16_bf16 v[56:71], v[204:207], v[140:143], v[56:71]
  v_exp_f32 v108, v108
  v_exp_f32 v109, v109
  v_exp_f32 v110, v110
  v_exp_f32 v111, v111
  v_cvt_pk_bf16_f32 v138, v108, v109
  v_cvt_pk_bf16_f32 v139, v110, v111
  v_mfma_f32_32x32x16_bf16 v[120:135], v[172:175], v[36:39], v[120:135]
  v_exp_f32 v112, v112
  v_exp_f32 v113, v113
  v_exp_f32 v114, v114
  v_exp_f32 v115, v115
  v_cvt_pk_bf16_f32 v140, v112, v113
  v_cvt_pk_bf16_f32 v141, v114, v115
  v_mfma_f32_32x32x16_bf16 v[72:87], v[200:203], v[136:139], v[72:87]
  v_exp_f32 v116, v116
  v_exp_f32 v117, v117
  v_exp_f32 v118, v118
  v_exp_f32 v119, v119
  v_cvt_pk_bf16_f32 v142, v116, v117
  v_cvt_pk_bf16_f32 v143, v118, v119
  v_mfma_f32_32x32x16_bf16 v[104:119], v[160:163], v[8:11], 0
  v_exp_f32 v120, v120
  v_exp_f32 v121, v121
  v_exp_f32 v122, v122
  v_exp_f32 v123, v123
  v_cvt_pk_bf16_f32 v136, v120, v121
  v_cvt_pk_bf16_f32 v137, v122, v123
  v_mfma_f32_32x32x16_bf16 v[72:87], v[204:207], v[140:143], v[72:87]
  v_exp_f32 v124, v124
  v_exp_f32 v125, v125
  v_exp_f32 v126, v126
  v_exp_f32 v127, v127
  v_cvt_pk_bf16_f32 v138, v124, v125
  v_cvt_pk_bf16_f32 v139, v126, v127
  v_mfma_f32_32x32x16_bf16 v[104:119], v[164:167], v[12:15], v[104:119]
  v_xor_b32 v4, 4096, v5
  ds_write_b128 v4, v[56:59] offset:0
  ds_write_b128 v4, v[60:63] offset:1024
  v_exp_f32 v128, v128
  v_exp_f32 v129, v129
  v_exp_f32 v130, v130
  v_exp_f32 v131, v131
  v_cvt_pk_bf16_f32 v140, v128, v129
  v_cvt_pk_bf16_f32 v141, v130, v131
  v_mfma_f32_32x32x16_bf16 v[88:103], v[200:203], v[136:139], v[88:103]
  ds_write_b128 v4, v[64:67] offset:2048
  ds_write_b128 v4, v[68:71] offset:3072
  v_exp_f32 v132, v132
  v_exp_f32 v133, v133
  v_exp_f32 v134, v134
  v_exp_f32 v135, v135
  v_cvt_pk_bf16_f32 v142, v132, v133
  v_cvt_pk_bf16_f32 v143, v134, v135
  v_mfma_f32_32x32x16_bf16 v[120:135], v[168:171], v[8:11], 0
  v_xor_b32 v4, 8192, v5
  ds_write_b128 v4, v[72:75] offset:16384
  ds_write_b128 v4, v[76:79] offset:17408
  v_exp_f32 v104, v104
  v_exp_f32 v105, v105
  v_exp_f32 v106, v106
  v_exp_f32 v107, v107
  v_cvt_pk_bf16_f32 v136, v104, v105
  v_cvt_pk_bf16_f32 v137, v106, v107
  v_mfma_f32_32x32x16_bf16 v[88:103], v[204:207], v[140:143], v[88:103]
  ds_write_b128 v4, v[80:83] offset:18432
  ds_write_b128 v4, v[84:87] offset:19456
  v_exp_f32 v108, v108
  v_exp_f32 v109, v109
  v_exp_f32 v110, v110
  v_exp_f32 v111, v111
  v_cvt_pk_bf16_f32 v138, v108, v109
  v_cvt_pk_bf16_f32 v139, v110, v111
  v_mfma_f32_32x32x16_bf16 v[120:135], v[172:175], v[12:15], v[120:135]
  v_exp_f32 v112, v112
  v_exp_f32 v113, v113
  v_exp_f32 v114, v114
  v_exp_f32 v115, v115
  v_cvt_pk_bf16_f32 v140, v112, v113
  v_cvt_pk_bf16_f32 v141, v114, v115
  v_mfma_f32_32x32x16_bf16 v[40:55], v[192:195], v[136:139], v[40:55]
  v_exp_f32 v116, v116
  v_exp_f32 v117, v117
  v_exp_f32 v118, v118
  v_exp_f32 v119, v119
  v_cvt_pk_bf16_f32 v142, v116, v117
  v_cvt_pk_bf16_f32 v143, v118, v119
  v_xor_b32 v4, 12288, v5
  ds_write_b128 v4, v[88:91] offset:32768
  v_exp_f32 v120, v120
  v_exp_f32 v121, v121
  v_exp_f32 v122, v122
  v_exp_f32 v123, v123
  v_cvt_pk_bf16_f32 v136, v120, v121
  v_cvt_pk_bf16_f32 v137, v122, v123
  v_mfma_f32_32x32x16_bf16 v[40:55], v[196:199], v[140:143], v[40:55]
  ds_write_b128 v4, v[92:95] offset:33792
  ds_write_b128 v4, v[96:99] offset:34816
  v_exp_f32 v124, v124
  v_exp_f32 v125, v125
  v_exp_f32 v126, v126
  v_exp_f32 v127, v127
  v_cvt_pk_bf16_f32 v138, v124, v125
  v_cvt_pk_bf16_f32 v139, v126, v127
  ds_write_b128 v4, v[100:103] offset:35840
  v_exp_f32 v128, v128
  v_exp_f32 v129, v129
  v_exp_f32 v130, v130
  v_exp_f32 v131, v131
  v_cvt_pk_bf16_f32 v140, v128, v129
  v_cvt_pk_bf16_f32 v141, v130, v131
  v_mfma_f32_32x32x16_bf16 v[40:55], v[200:203], v[136:139], v[40:55]
  v_exp_f32 v132, v132
  v_exp_f32 v133, v133
  v_exp_f32 v134, v134
  v_exp_f32 v135, v135
  v_cvt_pk_bf16_f32 v142, v132, v133
  v_cvt_pk_bf16_f32 v143, v134, v135
  s_nop 1
  v_mfma_f32_32x32x16_bf16 v[40:55], v[204:207], v[140:143], v[40:55]
  s_lshl_b32 s52, s39, 2
  s_add_u32 s52, s52, s3
  s_lshl_b32 s53, s39, 4
  s_add_u32 s53, s53, s38
  s_lshl_b32 s53, s53, 7
  s_add_u32 s53, s53, 3964928
  s_lshl_b32 s52, s52, 15
  s_lshl_b32 s57, s38, 11
  s_add_u32 s52, s52, s57
  s_add_u32 s52, s52, 8388608
  s_lshl_b32 s55, s47, 11
  s_add_u32 s55, s55, 3964928
  v_mov_b32 v108, s40
  v_mov_b32 v109, s41
  v_mov_b32 v106, 0x12800000
  s_waitcnt lgkmcnt(0)
  s_barrier
  ds_read_b128 v[56:59], v5 offset:0
  ds_read_b128 v[60:63], v5 offset:1024
  ds_read_b128 v[64:67], v5 offset:2048
  ds_read_b128 v[68:71], v5 offset:3072
  ds_read_b128 v[72:75], v5 offset:16384
  ds_read_b128 v[76:79], v5 offset:17408
  ds_read_b128 v[80:83], v5 offset:18432
  ds_read_b128 v[84:87], v5 offset:19456
  ds_read_b128 v[88:91], v5 offset:32768
  ds_read_b128 v[92:95], v5 offset:33792
  ds_read_b128 v[96:99], v5 offset:34816
  ds_read_b128 v[100:103], v5 offset:35840
  s_waitcnt lgkmcnt(11)
  v_pk_add_f32 v[40:41], v[40:41], v[56:57]
  v_pk_add_f32 v[42:43], v[42:43], v[58:59]
  s_waitcnt lgkmcnt(10)
  v_pk_add_f32 v[44:45], v[44:45], v[60:61]
  v_pk_add_f32 v[46:47], v[46:47], v[62:63]
  s_waitcnt lgkmcnt(9)
  v_pk_add_f32 v[48:49], v[48:49], v[64:65]
  v_pk_add_f32 v[50:51], v[50:51], v[66:67]
  s_waitcnt lgkmcnt(8)
  v_pk_add_f32 v[52:53], v[52:53], v[68:69]
  v_pk_add_f32 v[54:55], v[54:55], v[70:71]
  s_waitcnt lgkmcnt(7)
  v_pk_add_f32 v[40:41], v[40:41], v[72:73]
  v_pk_add_f32 v[42:43], v[42:43], v[74:75]
  s_waitcnt lgkmcnt(6)
  v_pk_add_f32 v[44:45], v[44:45], v[76:77]
  v_pk_add_f32 v[46:47], v[46:47], v[78:79]
  s_waitcnt lgkmcnt(5)
  v_pk_add_f32 v[48:49], v[48:49], v[80:81]
  v_pk_add_f32 v[50:51], v[50:51], v[82:83]
  s_waitcnt lgkmcnt(4)
  v_pk_add_f32 v[52:53], v[52:53], v[84:85]
  v_pk_add_f32 v[54:55], v[54:55], v[86:87]
  s_waitcnt lgkmcnt(3)
  v_pk_add_f32 v[40:41], v[40:41], v[88:89]
  v_pk_add_f32 v[42:43], v[42:43], v[90:91]
  s_waitcnt lgkmcnt(2)
  v_pk_add_f32 v[44:45], v[44:45], v[92:93]
  v_pk_add_f32 v[46:47], v[46:47], v[94:95]
  s_waitcnt lgkmcnt(1)
  v_pk_add_f32 v[48:49], v[48:49], v[96:97]
  v_pk_add_f32 v[50:51], v[50:51], v[98:99]
  s_waitcnt lgkmcnt(0)
  v_pk_add_f32 v[52:53], v[52:53], v[100:101]
  v_pk_add_f32 v[54:55], v[54:55], v[102:103]
  v_mov_b32 v104, v52
  v_mov_b32 v105, v52
  s_nop 1
  v_permlane32_swap_b32 v105, v104
  v_cmp_nge_f32 vcc, v104, v106
  v_rcp_f32 v104, v104
  s_nop 3
  s_cbranch_vccnz L_attn_slow
L_attn_store:
  s_nop 3
  v_bfi_b32 v52, v3, 0, v52
  v_pk_mul_f32 v[40:41], v[40:41], v[104:105] op_sel_hi:[1,0]
  v_pk_mul_f32 v[42:43], v[42:43], v[104:105] op_sel_hi:[1,0]
  v_pk_mul_f32 v[44:45], v[44:45], v[104:105] op_sel_hi:[1,0]
  v_pk_mul_f32 v[46:47], v[46:47], v[104:105] op_sel_hi:[1,0]
  v_cvt_pk_bf16_f32 v136, v40, v41
  v_cvt_pk_bf16_f32 v137, v42, v43
  v_cvt_pk_bf16_f32 v138, v44, v45
  v_cvt_pk_bf16_f32 v139, v46, v47
  buffer_store_dwordx4 v[136:139], v2, s[24:27], s52 offen offset:0 sc1
  v_pk_mul_f32 v[48:49], v[48:49], v[104:105] op_sel_hi:[1,0]
  v_pk_mul_f32 v[50:51], v[50:51], v[104:105] op_sel_hi:[1,0]
  v_pk_mul_f32 v[52:53], v[52:53], v[104:105] op_sel_hi:[1,0]
  v_pk_mul_f32 v[54:55], v[54:55], v[104:105] op_sel_hi:[1,0]
  v_cvt_pk_bf16_f32 v140, v48, v49
  v_cvt_pk_bf16_f32 v141, v50, v51
  v_cvt_pk_bf16_f32 v142, v52, v53
  v_cvt_pk_bf16_f32 v143, v54, v55
  buffer_store_dwordx4 v[140:143], v2, s[24:27], s52 offen offset:1024 sc1
  s_waitcnt vmcnt(0)
  s_barrier
  s_cmp_lg_u32 s3, 0
  s_cbranch_scc1 Lpub_sequential_preLN__mha_block__dense_activation_silu__prompt_kernel_11
  s_mov_b64 exec, 0x1
  buffer_store_dwordx2 v[108:109], off, s[24:27], s53  sc1
  s_mov_b64 exec, -1
Lpub_sequential_preLN__mha_block__dense_activation_silu__prompt_kernel_11:
  s_cmp_ge_u32 s37, 28
  s_cbranch_scc1 L_end
  s_mul_i32 s50, s3, 28672
  v_add_u32 v197, s50, v2
  v_mov_b32 v196, 0x3f803f80
  v_mov_b32 v192, 0
  v_mov_b32 v193, 0
  v_mov_b32 v194, 0
  v_mov_b32 v195, 0
  ds_read_b128 v[8:11], v197 offset:0
  ds_read_b128 v[12:15], v197 offset:1024
  ds_read_b128 v[16:19], v197 offset:2048
  ds_read_b128 v[20:23], v197 offset:3072
  ds_read_b128 v[24:27], v197 offset:4096
  ds_read_b128 v[28:31], v197 offset:5120
  ds_read_b128 v[32:35], v197 offset:6144
  ds_read_b128 v[36:39], v197 offset:7168
  ds_read_b128 v[40:43], v197 offset:8192
  ds_read_b128 v[44:47], v197 offset:9216
  ds_read_b128 v[48:51], v197 offset:10240
  ds_read_b128 v[52:55], v197 offset:11264
  s_waitcnt lgkmcnt(11)
  v_dot2c_f32_bf16 v192, v8, v196
  v_dot2c_f32_bf16 v193, v9, v196
  v_dot2c_f32_bf16 v194, v10, v196
  v_dot2c_f32_bf16 v195, v11, v196
  ds_read_b128 v[8:11], v197 offset:12288
  s_waitcnt lgkmcnt(11)
  v_dot2c_f32_bf16 v192, v12, v196
  v_dot2c_f32_bf16 v193, v13, v196
  v_dot2c_f32_bf16 v194, v14, v196
  v_dot2c_f32_bf16 v195, v15, v196
  ds_read_b128 v[12:15], v197 offset:13312
  s_waitcnt lgkmcnt(11)
  v_dot2c_f32_bf16 v192, v16, v196
  v_dot2c_f32_bf16 v193, v17, v196
  v_dot2c_f32_bf16 v194, v18, v196
  v_dot2c_f32_bf16 v195, v19, v196
  ds_read_b128 v[16:19], v197 offset:14336
  s_waitcnt lgkmcnt(11)
  v_dot2c_f32_bf16 v192, v20, v196
  v_dot2c_f32_bf16 v193, v21, v196
  v_dot2c_f32_bf16 v194, v22, v196
  v_dot2c_f32_bf16 v195, v23, v196
  ds_read_b128 v[20:23], v197 offset:15360
  s_waitcnt lgkmcnt(11)
  v_dot2c_f32_bf16 v192, v24, v196
  v_dot2c_f32_bf16 v193, v25, v196
  v_dot2c_f32_bf16 v194, v26, v196
  v_dot2c_f32_bf16 v195, v27, v196
  ds_read_b128 v[24:27], v197 offset:16384
  s_waitcnt lgkmcnt(11)
  v_dot2c_f32_bf16 v192, v28, v196
  v_dot2c_f32_bf16 v193, v29, v196
  v_dot2c_f32_bf16 v194, v30, v196
  v_dot2c_f32_bf16 v195, v31, v196
  ds_read_b128 v[28:31], v197 offset:17408
  s_waitcnt lgkmcnt(11)
  v_dot2c_f32_bf16 v192, v32, v196
  v_dot2c_f32_bf16 v193, v33, v196
  v_dot2c_f32_bf16 v194, v34, v196
  v_dot2c_f32_bf16 v195, v35, v196
  ds_read_b128 v[32:35], v197 offset:18432
  s_waitcnt lgkmcnt(11)
  v_dot2c_f32_bf16 v192, v36, v196
  v_dot2c_f32_bf16 v193, v37, v196
  v_dot2c_f32_bf16 v194, v38, v196
  v_dot2c_f32_bf16 v195, v39, v196
  ds_read_b128 v[36:39], v197 offset:19456
  s_waitcnt lgkmcnt(11)
  v_dot2c_f32_bf16 v192, v40, v196
  v_dot2c_f32_bf16 v193, v41, v196
  v_dot2c_f32_bf16 v194, v42, v196
  v_dot2c_f32_bf16 v195, v43, v196
  s_waitcnt lgkmcnt(10)
  v_dot2c_f32_bf16 v192, v44, v196
  v_dot2c_f32_bf16 v193, v45, v196
  v_dot2c_f32_bf16 v194, v46, v196
  v_dot2c_f32_bf16 v195, v47, v196
  s_waitcnt lgkmcnt(9)
  v_dot2c_f32_bf16 v192, v48, v196
  v_dot2c_f32_bf16 v193, v49, v196
  v_dot2c_f32_bf16 v194, v50, v196
  v_dot2c_f32_bf16 v195, v51, v196
  s_waitcnt lgkmcnt(8)
  v_dot2c_f32_bf16 v192, v52, v196
  v_dot2c_f32_bf16 v193, v53, v196
  v_dot2c_f32_bf16 v194, v54, v196
  v_dot2c_f32_bf16 v195, v55, v196
  s_waitcnt lgkmcnt(7)
  v_dot2c_f32_bf16 v192, v8, v196
  v_dot2c_f32_bf16 v193, v9, v196
  v_dot2c_f32_bf16 v194, v10, v196
  v_dot2c_f32_bf16 v195, v11, v196
  s_waitcnt lgkmcnt(6)
  v_dot2c_f32_bf16 v192, v12, v196
  v_dot2c_f32_bf16 v193, v13, v196
  v_dot2c_f32_bf16 v194, v14, v196
  v_dot2c_f32_bf16 v195, v15, v196
  s_waitcnt lgkmcnt(5)
  v_dot2c_f32_bf16 v192, v16, v196
  v_dot2c_f32_bf16 v193, v17, v196
  v_dot2c_f32_bf16 v194, v18, v196
  v_dot2c_f32_bf16 v195, v19, v196
  s_waitcnt lgkmcnt(4)
  v_dot2c_f32_bf16 v192, v20, v196
  v_dot2c_f32_bf16 v193, v21, v196
  v_dot2c_f32_bf16 v194, v22, v196
  v_dot2c_f32_bf16 v195, v23, v196
  s_waitcnt lgkmcnt(3)
  v_dot2c_f32_bf16 v192, v24, v196
  v_dot2c_f32_bf16 v193, v25, v196
  v_dot2c_f32_bf16 v194, v26, v196
  v_dot2c_f32_bf16 v195, v27, v196
  s_waitcnt lgkmcnt(2)
  v_dot2c_f32_bf16 v192, v28, v196
  v_dot2c_f32_bf16 v193, v29, v196
  v_dot2c_f32_bf16 v194, v30, v196
  v_dot2c_f32_bf16 v195, v31, v196
  s_waitcnt lgkmcnt(1)
  v_dot2c_f32_bf16 v192, v32, v196
  v_dot2c_f32_bf16 v193, v33, v196
  v_dot2c_f32_bf16 v194, v34, v196
  v_dot2c_f32_bf16 v195, v35, v196
  s_waitcnt lgkmcnt(0)
  v_dot2c_f32_bf16 v192, v36, v196
  v_dot2c_f32_bf16 v193, v37, v196
  v_dot2c_f32_bf16 v194, v38, v196
  v_dot2c_f32_bf16 v195, v39, v196
  s_lshl_b32 s54, s13, 15
  s_xor_b32 s56, s54, 0x8000
  s_lshl_b32 s57, s3, 13
  s_add_u32 s57, s57, 8388608
  s_add_u32 s54, s54, s57
  s_add_u32 s56, s56, s57
  v_lshlrev_b32 v7, 7, v0
  s_add_u32 s58, s44, 0
  s_and_b32 s58, s58, 3
  s_lshl_b32 s58, s58, 11
  v_add_u32 v200, s58, v2
  s_add_u32 s58, s44, 1
  s_and_b32 s58, s58, 3
  s_lshl_b32 s58, s58, 11
  v_add_u32 v201, s58, v2
  s_add_u32 s58, s44, 2
  s_and_b32 s58, s58, 3
  s_lshl_b32 s58, s58, 11
  v_add_u32 v202, s58, v2
  s_add_u32 s58, s44, 3
  s_and_b32 s58, s58, 3
  s_lshl_b32 s58, s58, 11
  v_add_u32 v203, s58, v2
  s_lshl_b32 s58, s3, 9
  s_add_u32 s55, s55, s58
  s_mov_b64 exec, 0xf
  s_mov_b32 s50, 0
Lpoll_sequential_preLN__mha_block__dense_activation_silu__prompt_kernel_12:
  buffer_load_dwordx2 v[110:111], v7, s[24:27], s55 offen sc1
  s_add_u32 s50, s50, 1
  s_waitcnt vmcnt(0)
  v_cmp_ne_u64 vcc, s[40:41], v[110:111]
  s_cmp_ge_u32 s50, 200000
  s_cbranch_scc1 Lpollo_sequential_preLN__mha_block__dense_activation_silu__prompt_kernel_13
  s_nop 2
  s_cbranch_vccnz Lpoll_sequential_preLN__mha_block__dense_activation_silu__prompt_kernel_12
Lpollo_sequential_preLN__mha_block__dense_activation_silu__prompt_kernel_13:
  s_mov_b64 exec, -1
Lpolls_sequential_preLN__mha_block__dense_activation_silu__prompt_kernel_14:
  buffer_load_dwordx4 v[72:75], v200, s[24:27], s54 offen offset:0 sc1
  buffer_load_dwordx4 v[76:79], v200, s[24:27], s56 offen offset:0 sc1
  buffer_load_dwordx4 v[80:83], v200, s[24:27], s54 offen offset:1024 sc1
  buffer_load_dwordx4 v[84:87], v200, s[24:27], s56 offen offset:1024 sc1
  buffer_load_dwordx4 v[88:91], v201, s[24:27], s54 offen offset:0 sc1
  buffer_load_dwordx4 v[92:95], v201, s[24:27], s56 offen offset:0 sc1
  buffer_load_dwordx4 v[96:99], v201, s[24:27], s54 offen offset:1024 sc1
  buffer_load_dwordx4 v[100:103], v201, s[24:27], s56 offen offset:1024 sc1
  buffer_load_dwordx4 v[104:107], v202, s[24:27], s54 offen offset:0 sc1
  buffer_load_dwordx4 v[108:111], v202, s[24:27], s56 offen offset:0 sc1
  buffer_load_dwordx4 v[112:115], v202, s[24:27], s54 offen offset:1024 sc1
  buffer_load_dwordx4 v[116:119], v202, s[24:27], s56 offen offset:1024 sc1
  buffer_load_dwordx4 v[120:123], v203, s[24:27], s54 offen offset:0 sc1
  buffer_load_dwordx4 v[124:127], v203, s[24:27], s56 offen offset:0 sc1
  buffer_load_dwordx4 v[128:131], v203, s[24:27], s54 offen offset:1024 sc1
  buffer_load_dwordx4 v[132:135], v203, s[24:27], s56 offen offset:1024 sc1
  s_mul_i32 s52, s13, 28672
  s_lshl_b32 s53, s12, 11
  s_add_u32 s52, s52, s53
  s_add_u32 s52, s52, 10485760
  s_mul_i32 s53, s13, 14
  s_add_u32 s53, s53, s12
  s_lshl_b32 s53, s53, 8
  s_add_u32 s53, s53, 3670016
  s_lshl_b32 s55, s47, 11
  s_add_u32 s55, s55, 19660800
  s_lshl_b32 s57, s46, 7
  s_add_u32 s57, s57, s55
  v_mov_b32 v156, s40
  v_mov_b32 v157, s41
  v_mov_b32 v152, 0
  v_mov_b32 v153, 0
  v_mov_b32 v154, 0
  v_mov_b32 v155, 0
  v_mov_b32 v160, 0x3f803f80
  v_permlane32_swap_b32 v208, v210
  v_permlane32_swap_b32 v209, v211
  v_permlane32_swap_b32 v212, v214
  v_permlane32_swap_b32 v213, v215
  v_lshlrev_b32 v168, 16, v208
  v_and_b32 v169, 0xffff0000, v208
  v_lshlrev_b32 v170, 16, v209
  v_and_b32 v171, 0xffff0000, v209
  v_lshlrev_b32 v172, 16, v210
  v_and_b32 v173, 0xffff0000, v210
  v_lshlrev_b32 v174, 16, v211
  v_and_b32 v175, 0xffff0000, v211
  v_lshlrev_b32 v176, 16, v212
  v_and_b32 v177, 0xffff0000, v212
  v_lshlrev_b32 v178, 16, v213
  v_and_b32 v179, 0xffff0000, v213
  v_lshlrev_b32 v180, 16, v214
  v_and_b32 v181, 0xffff0000, v214
  v_lshlrev_b32 v182, 16, v215
  v_and_b32 v183, 0xffff0000, v215
  s_waitcnt vmcnt(14)
  v_mfma_f32_32x32x16_bf16 v[56:71], v[224:227], v[76:79], 0
  v_mfma_f32_32x32x16_bf16 v[40:55], v[224:227], v[72:75], 0
  v_mfma_f32_32x32x16_bf16 v[24:39], a[224:227], v[76:79], 0
  v_mfma_f32_32x32x16_bf16 v[8:23], a[224:227], v[72:75], v[168:183]
  s_waitcnt vmcnt(12)
  v_mfma_f32_32x32x16_bf16 v[56:71], v[228:231], v[84:87], v[56:71]
  v_mfma_f32_32x32x16_bf16 v[40:55], v[228:231], v[80:83], v[40:55]
  v_mfma_f32_32x32x16_bf16 v[24:39], a[228:231], v[84:87], v[24:39]
  v_mfma_f32_32x32x16_bf16 v[8:23], a[228:231], v[80:83], v[8:23]
  s_waitcnt vmcnt(10)
  v_mfma_f32_32x32x16_bf16 v[56:71], v[232:235], v[92:95], v[56:71]
  v_mfma_f32_32x32x16_bf16 v[40:55], v[232:235], v[88:91], v[40:55]
  v_mfma_f32_32x32x16_bf16 v[24:39], a[232:235], v[92:95], v[24:39]
  v_mfma_f32_32x32x16_bf16 v[8:23], a[232:235], v[88:91], v[8:23]
  s_waitcnt vmcnt(8)
  v_mfma_f32_32x32x16_bf16 v[56:71], v[236:239], v[100:103], v[56:71]
  v_mfma_f32_32x32x16_bf16 v[40:55], v[236:239], v[96:99], v[40:55]
  v_mfma_f32_32x32x16_bf16 v[24:39], a[236:239], v[100:103], v[24:39]
  v_mfma_f32_32x32x16_bf16 v[8:23], a[236:239], v[96:99], v[8:23]
  s_waitcnt vmcnt(6)
  v_mfma_f32_32x32x16_bf16 v[56:71], v[240:243], v[108:111], v[56:71]
  v_mfma_f32_32x32x16_bf16 v[40:55], v[240:243], v[104:107], v[40:55]
  v_mfma_f32_32x32x16_bf16 v[24:39], a[240:243], v[108:111], v[24:39]
  v_mfma_f32_32x32x16_bf16 v[8:23], a[240:243], v[104:107], v[8:23]
  s_waitcnt vmcnt(4)
  v_mfma_f32_32x32x16_bf16 v[56:71], v[244:247], v[116:119], v[56:71]
  v_mfma_f32_32x32x16_bf16 v[40:55], v[244:247], v[112:115], v[40:55]
  v_mfma_f32_32x32x16_bf16 v[24:39], a[244:247], v[116:119], v[24:39]
  v_mfma_f32_32x32x16_bf16 v[8:23], a[244:247], v[112:115], v[8:23]
  s_waitcnt vmcnt(2)
  v_mfma_f32_32x32x16_bf16 v[56:71], v[248:251], v[124:127], v[56:71]
  v_mfma_f32_32x32x16_bf16 v[40:55], v[248:251], v[120:123], v[40:55]
  v_mfma_f32_32x32x16_bf16 v[24:39], a[248:251], v[124:127], v[24:39]
  v_mfma_f32_32x32x16_bf16 v[8:23], a[248:251], v[120:123], v[8:23]
  s_waitcnt vmcnt(0)
  v_mfma_f32_32x32x16_bf16 v[56:71], v[252:255], v[132:135], v[56:71]
  v_mfma_f32_32x32x16_bf16 v[40:55], v[252:255], v[128:131], v[40:55]
  v_mfma_f32_32x32x16_bf16 v[24:39], a[252:255], v[132:135], v[24:39]
  v_mfma_f32_32x32x16_bf16 v[8:23], a[252:255], v[128:131], v[8:23]
  v_xor_b32 v4, 12288, v5
  s_nop 7
  ds_write_b128 v4, v[56:59] offset:32768
  ds_write_b128 v4, v[60:63] offset:33792
  ds_write_b128 v4, v[64:67] offset:34816
  ds_write_b128 v4, v[68:71] offset:35840
  v_xor_b32 v4, 8192, v5
  ds_write_b128 v4, v[40:43] offset:16384
  ds_write_b128 v4, v[44:47] offset:17408
  ds_write_b128 v4, v[48:51] offset:18432
  ds_write_b128 v4, v[52:55] offset:19456
  v_xor_b32 v4, 4096, v5
  ds_write_b128 v4, v[24:27] offset:0
  ds_write_b128 v4, v[28:31] offset:1024
  ds_write_b128 v4, v[32:35] offset:2048
  ds_write_b128 v4, v[36:39] offset:3072
  s_waitcnt lgkmcnt(0)
  s_barrier
  ds_read_b128 v[24:27], v5 offset:0
  ds_read_b128 v[28:31], v5 offset:1024
  ds_read_b128 v[32:35], v5 offset:2048
  ds_read_b128 v[36:39], v5 offset:3072
  ds_read_b128 v[40:43], v5 offset:16384
  ds_read_b128 v[44:47], v5 offset:17408
  ds_read_b128 v[48:51], v5 offset:18432
  ds_read_b128 v[52:55], v5 offset:19456
  ds_read_b128 v[56:59], v5 offset:32768
  ds_read_b128 v[60:63], v5 offset:33792
  ds_read_b128 v[64:67], v5 offset:34816
  ds_read_b128 v[68:71], v5 offset:35840
  s_waitcnt lgkmcnt(11)
  v_pk_add_f32 v[8:9], v[8:9], v[24:25]
  v_pk_add_f32 v[10:11], v[10:11], v[26:27]
  s_waitcnt lgkmcnt(10)
  v_pk_add_f32 v[12:13], v[12:13], v[28:29]
  v_pk_add_f32 v[14:15], v[14:15], v[30:31]
  s_waitcnt lgkmcnt(9)
  v_pk_add_f32 v[16:17], v[16:17], v[32:33]
  v_pk_add_f32 v[18:19], v[18:19], v[34:35]
  s_waitcnt lgkmcnt(8)
  v_pk_add_f32 v[20:21], v[20:21], v[36:37]
  v_pk_add_f32 v[22:23], v[22:23], v[38:39]
  s_waitcnt lgkmcnt(7)
  v_pk_add_f32 v[8:9], v[8:9], v[40:41]
  v_pk_add_f32 v[10:11], v[10:11], v[42:43]
  s_waitcnt lgkmcnt(6)
  v_pk_add_f32 v[12:13], v[12:13], v[44:45]
  v_pk_add_f32 v[14:15], v[14:15], v[46:47]
  s_waitcnt lgkmcnt(5)
  v_pk_add_f32 v[16:17], v[16:17], v[48:49]
  v_pk_add_f32 v[18:19], v[18:19], v[50:51]
  s_waitcnt lgkmcnt(4)
  v_pk_add_f32 v[20:21], v[20:21], v[52:53]
  v_pk_add_f32 v[22:23], v[22:23], v[54:55]
  s_waitcnt lgkmcnt(3)
  v_pk_add_f32 v[8:9], v[8:9], v[56:57]
  v_pk_add_f32 v[10:11], v[10:11], v[58:59]
  s_waitcnt lgkmcnt(2)
  v_pk_add_f32 v[12:13], v[12:13], v[60:61]
  v_pk_add_f32 v[14:15], v[14:15], v[62:63]
  s_waitcnt lgkmcnt(1)
  v_pk_add_f32 v[16:17], v[16:17], v[64:65]
  v_pk_add_f32 v[18:19], v[18:19], v[66:67]
  s_waitcnt lgkmcnt(0)
  v_pk_add_f32 v[20:21], v[20:21], v[68:69]
  v_pk_add_f32 v[22:23], v[22:23], v[70:71]
  v_cvt_pk_bf16_f32 v216, v8, v9
  v_cvt_pk_bf16_f32 v217, v10, v11
  v_cvt_pk_bf16_f32 v218, v12, v13
  v_cvt_pk_bf16_f32 v219, v14, v15
  buffer_store_dwordx4 v[216:219], v2, s[24:27], s52 offen offset:0 sc1
  v_cvt_pk_bf16_f32 v220, v16, v17
  v_cvt_pk_bf16_f32 v221, v18, v19
  v_cvt_pk_bf16_f32 v222, v20, v21
  v_cvt_pk_bf16_f32 v223, v22, v23
  buffer_store_dwordx4 v[220:223], v2, s[24:27], s52 offen offset:1024 sc1
  v_dot2c_f32_bf16 v152, v216, v160
  v_dot2c_f32_bf16 v153, v216, v216
  v_dot2c_f32_bf16 v154, v217, v160
  v_dot2c_f32_bf16 v155, v217, v217
  v_dot2c_f32_bf16 v152, v218, v160
  v_dot2c_f32_bf16 v153, v218, v218
  v_dot2c_f32_bf16 v154, v219, v160
  v_dot2c_f32_bf16 v155, v219, v219
  v_dot2c_f32_bf16 v152, v220, v160
  v_dot2c_f32_bf16 v153, v220, v220
  v_dot2c_f32_bf16 v154, v221, v160
  v_dot2c_f32_bf16 v155, v221, v221
  v_dot2c_f32_bf16 v152, v222, v160
  v_dot2c_f32_bf16 v153, v222, v222
  v_dot2c_f32_bf16 v154, v223, v160
  v_dot2c_f32_bf16 v155, v223, v223
  s_nop 1
  v_add_f32 v152, v152, v154
  v_add_f32 v153, v153, v155
  v_mov_b32 v154, v152
  v_mov_b32 v155, v153
  s_nop 0
  v_permlane32_swap_b32 v154, v152
  v_permlane32_swap_b32 v155, v153
  v_add_f32 v152, v152, v154
  v_add_f32 v153, v153, v155
  s_mov_b64 exec, 0xffffffff
  buffer_store_dwordx2 v[152:153], v1, s[24:27], s53 offen sc1
  s_mov_b64 exec, -1
  s_lshl_b32 s53, s47, 2
  s_add_u32 s53, s53, s3
  v_add_u32 v3, 0x10000, v2
  s_mul_i32 s54, s53, 28672
  s_add_u32 s54, s54, 10485760
  s_mul_i32 s56, s53, 3584
  s_add_u32 s56, s56, 3670016
  v_and_b32 v4, 31, v0
  v_lshlrev_b32 v4, 3, v4
  v_lshrrev_b32 v5, 5, v0
  v_mul_u32_u24 v232, 1792, v5
  v_add_u32 v4, v4, v232
  v_cvt_f32_u32 v230, v5
  v_sub_f32 v230, 1.0, v230
  s_mul_i32 s58, s53, 114688
  s_lshl_b32 s59, s46, 13
  s_add_u32 s58, s58, s59
  s_add_u32 s58, s58, 12320768
  s_add_u32 s59, s58, 4096
  s_lshl_b32 s61, s47, 13
  s_add_u32 s61, s61, 19693568
  s_add_u32 s62, s61, 2048
  s_add_u32 s15, s61, 4096
  s_lshl_b32 s60, s46, 7
  s_add_u32 s63, s60, s62
  s_add_u32 s49, s60, s15
  s_add_u32 s60, s60, s61
  v_mov_b32 v226, 0
  v_mov_b32 v227, 0
  v_mov_b32 v240, s40
  v_mov_b32 v241, s41
  s_lshl_b32 s10, s46, 11
  s_add_u32 s64, s54, s10
  s_add_u32 s10, s10, 2048
  s_cmp_eq_u32 s10, 28672
  s_cselect_b32 s10, 0, s10
  s_add_u32 s65, s54, s10
  s_add_u32 s10, s10, 2048
  s_cmp_eq_u32 s10, 28672
  s_cselect_b32 s10, 0, s10
  s_add_u32 s66, s54, s10
  s_add_u32 s10, s10, 2048
  s_cmp_eq_u32 s10, 28672
  s_cselect_b32 s10, 0, s10
  s_add_u32 s67, s54, s10
  s_add_u32 s10, s10, 2048
  s_cmp_eq_u32 s10, 28672
  s_cselect_b32 s10, 0, s10
  s_add_u32 s68, s54, s10
  s_add_u32 s10, s10, 2048
  s_cmp_eq_u32 s10, 28672
  s_cselect_b32 s10, 0, s10
  s_add_u32 s69, s54, s10
  s_add_u32 s10, s10, 2048
  s_cmp_eq_u32 s10, 28672
  s_cselect_b32 s10, 0, s10
  s_add_u32 s70, s54, s10
  s_add_u32 s10, s10, 2048
  s_cmp_eq_u32 s10, 28672
  s_cselect_b32 s10, 0, s10
  s_add_u32 s71, s54, s10
  s_add_u32 s10, s10, 2048
  s_cmp_eq_u32 s10, 28672
  s_cselect_b32 s10, 0, s10
  s_add_u32 s72, s54, s10
  s_add_u32 s10, s10, 2048
  s_cmp_eq_u32 s10, 28672
  s_cselect_b32 s10, 0, s10
  s_add_u32 s73, s54, s10
  s_add_u32 s10, s10, 2048
  s_cmp_eq_u32 s10, 28672
  s_cselect_b32 s10, 0, s10
  s_add_u32 s74, s54, s10
  s_add_u32 s10, s10, 2048
  s_cmp_eq_u32 s10, 28672
  s_cselect_b32 s10, 0, s10
  s_add_u32 s75, s54, s10
  s_add_u32 s10, s10, 2048
  s_cmp_eq_u32 s10, 28672
  s_cselect_b32 s10, 0, s10
  s_add_u32 s8, s54, s10
  s_add_u32 s10, s10, 2048
  s_cmp_eq_u32 s10, 28672
  s_cselect_b32 s10, 0, s10
  s_add_u32 s9, s54, s10
  s_waitcnt vmcnt(0)
  s_barrier
  s_cmp_lg_u32 s3, 0
  s_cbranch_scc1 Lpub_sequential_preLN__mha_block__dense_activation_silu__prompt_kernel_15
  s_mov_b64 exec, 0x1
  buffer_store_dwordx2 v[156:157], off, s[24:27], s57  sc1
  s_add_u32 s50, s57, 262144
  buffer_store_dwordx2 v[156:157], off, s[24:27], s50
  s_mov_b64 exec, -1
Lpub_sequential_preLN__mha_block__dense_activation_silu__prompt_kernel_15:
  s_mul_i32 s50, s3, 28672
  v_add_u32 v197, s50, v2
  ds_read_b128 v[8:11], v197 offset:20480
  ds_read_b128 v[12:15], v197 offset:21504
  ds_read_b128 v[16:19], v197 offset:22528
  ds_read_b128 v[20:23], v197 offset:23552
  ds_read_b128 v[24:27], v197 offset:24576
  ds_read_b128 v[28:31], v197 offset:25600
  ds_read_b128 v[32:35], v197 offset:26624
  ds_read_b128 v[36:39], v197 offset:27648
  s_waitcnt lgkmcnt(7)
  v_dot2c_f32_bf16 v192, v8, v196
  v_dot2c_f32_bf16 v193, v9, v196
  v_dot2c_f32_bf16 v194, v10, v196
  v_dot2c_f32_bf16 v195, v11, v196
  s_waitcnt lgkmcnt(6)
  v_dot2c_f32_bf16 v192, v12, v196
  v_dot2c_f32_bf16 v193, v13, v196
  v_dot2c_f32_bf16 v194, v14, v196
  v_dot2c_f32_bf16 v195, v15, v196
  s_waitcnt lgkmcnt(5)
  v_dot2c_f32_bf16 v192, v16, v196
  v_dot2c_f32_bf16 v193, v17, v196
  v_dot2c_f32_bf16 v194, v18, v196
  v_dot2c_f32_bf16 v195, v19, v196
  s_waitcnt lgkmcnt(4)
  v_dot2c_f32_bf16 v192, v20, v196
  v_dot2c_f32_bf16 v193, v21, v196
  v_dot2c_f32_bf16 v194, v22, v196
  v_dot2c_f32_bf16 v195, v23, v196
  s_waitcnt lgkmcnt(3)
  v_dot2c_f32_bf16 v192, v24, v196
  v_dot2c_f32_bf16 v193, v25, v196
  v_dot2c_f32_bf16 v194, v26, v196
  v_dot2c_f32_bf16 v195, v27, v196
  s_waitcnt lgkmcnt(2)
  v_dot2c_f32_bf16 v192, v28, v196
  v_dot2c_f32_bf16 v193, v29, v196
  v_dot2c_f32_bf16 v194, v30, v196
  v_dot2c_f32_bf16 v195, v31, v196
  s_waitcnt lgkmcnt(1)
  v_dot2c_f32_bf16 v192, v32, v196
  v_dot2c_f32_bf16 v193, v33, v196
  v_dot2c_f32_bf16 v194, v34, v196
  v_dot2c_f32_bf16 v195, v35, v196
  s_waitcnt lgkmcnt(0)
  v_dot2c_f32_bf16 v192, v36, v196
  v_dot2c_f32_bf16 v193, v37, v196
  v_dot2c_f32_bf16 v194, v38, v196
  v_dot2c_f32_bf16 v195, v39, v196
  s_nop 0
  v_add_f32 v192, v192, v193
  s_nop 0
  v_add_f32 v194, v194, v195
  v_add_f32 v192, v192, v194
  v_mov_b32 v193, v192
  s_nop 1
  v_permlane32_swap_b32 v193, v192
  v_add_f32 v192, v192, v193
  v_and_b32 v197, 31, v0
  v_lshlrev_b32 v197, 4, v197
  v_add_u32 v197, 114688, v197
  s_lshl_b32 s50, s3, 2
  v_add_u32 v193, s50, v197
  ds_write_b32 v193, v192
  s_waitcnt lgkmcnt(0)
  s_cmp_lg_u32 s3, 3
  s_cbranch_scc1 Lpolls_sequential_preLN__mha_block__dense_activation_silu__prompt_kernel_18
  s_mov_b64 exec, 0x3fff
  s_mov_b32 s50, 0
Lpoll_sequential_preLN__mha_block__dense_activation_silu__prompt_kernel_16:
  s_cmp_lt_u32 s50, 6
  s_cselect_b32 s51, 262144, 0
  s_add_u32 s51, s51, s55
  buffer_load_dwordx2 v[158:159], v7, s[24:27], s51 offen sc1
  s_add_u32 s50, s50, 1
  s_waitcnt vmcnt(0)
  v_cmp_ne_u64 vcc, s[40:41], v[158:159]
  s_cmp_ge_u32 s50, 200000
  s_cbranch_scc1 Lpollo_sequential_preLN__mha_block__dense_activation_silu__prompt_kernel_17
  s_nop 2
  s_cbranch_vccnz Lpoll_sequential_preLN__mha_block__dense_activation_silu__prompt_kernel_16
Lpollo_sequential_preLN__mha_block__dense_activation_silu__prompt_kernel_17:
  s_mov_b64 exec, -1
Lpolls_sequential_preLN__mha_block__dense_activation_silu__prompt_kernel_18:
  s_barrier
  ds_read_b128 v[236:239], v197
  buffer_load_dwordx2 v[200:201], v4, s[24:27], s56 offen offset:0 sc1
  buffer_load_dwordx2 v[202:203], v4, s[24:27], s56 offen offset:256 sc1
  buffer_load_dwordx2 v[204:205], v4, s[24:27], s56 offen offset:512 sc1
  buffer_load_dwordx2 v[206:207], v4, s[24:27], s56 offen offset:768 sc1
  buffer_load_dwordx2 v[208:209], v4, s[24:27], s56 offen offset:1024 sc1
  buffer_load_dwordx2 v[210:211], v4, s[24:27], s56 offen offset:1280 sc1
  buffer_load_dwordx2 v[212:213], v4, s[24:27], s56 offen offset:1536 sc1
  buffer_load_dwordx4 v[8:11], v2, s[24:27], s64 offen offset:0 sc1
  buffer_load_dwordx4 v[12:15], v2, s[24:27], s64 offen offset:1024 sc1
  buffer_load_dwordx4 v[16:19], v2, s[24:27], s65 offen offset:0 sc1
  buffer_load_dwordx4 v[20:23], v2, s[24:27], s65 offen offset:1024 sc1
  buffer_load_dwordx4 v[24:27], v2, s[24:27], s66 offen offset:0 sc1
  buffer_load_dwordx4 v[28:31], v2, s[24:27], s66 offen offset:1024 sc1
  buffer_load_dwordx4 v[32:35], v2, s[24:27], s67 offen offset:0 sc1
  buffer_load_dwordx4 v[36:39], v2, s[24:27], s67 offen offset:1024 sc1
  buffer_load_dwordx4 v[40:43], v2, s[24:27], s68 offen offset:0 sc1
  buffer_load_dwordx4 v[44:47], v2, s[24:27], s68 offen offset:1024 sc1
  buffer_load_dwordx4 v[48:51], v2, s[24:27], s69 offen offset:0 sc1
  buffer_load_dwordx4 v[52:55], v2, s[24:27], s69 offen offset:1024 sc1
  buffer_load_dwordx4 v[56:59], v2, s[24:27], s70 offen offset:0 sc1
  buffer_load_dwordx4 v[60:63], v2, s[24:27], s70 offen offset:1024 sc1
  buffer_load_dwordx4 v[64:67], v2, s[24:27], s71 offen offset:0 sc1
  buffer_load_dwordx4 v[68:71], v2, s[24:27], s71 offen offset:1024 sc1
  buffer_load_dwordx4 v[72:75], v2, s[24:27], s72 offen offset:0 sc1
  buffer_load_dwordx4 v[76:79], v2, s[24:27], s72 offen offset:1024 sc1
  buffer_load_dwordx4 v[80:83], v2, s[24:27], s73 offen offset:0 sc1
  buffer_load_dwordx4 v[84:87], v2, s[24:27], s73 offen offset:1024 sc1
  buffer_load_dwordx4 v[88:91], v2, s[24:27], s74 offen offset:0 sc1
  buffer_load_dwordx4 v[92:95], v2, s[24:27], s74 offen offset:1024 sc1
  buffer_load_dwordx4 v[96:99], v2, s[24:27], s75 offen offset:0 sc1
  buffer_load_dwordx4 v[100:103], v2, s[24:27], s75 offen offset:1024 sc1
  buffer_load_dwordx4 v[104:107], v2, s[24:27], s8 offen offset:0 sc1
  buffer_load_dwordx4 v[108:111], v2, s[24:27], s8 offen offset:1024 sc1
  buffer_load_dwordx4 v[112:115], v2, s[24:27], s9 offen offset:0 sc1
  buffer_load_dwordx4 v[116:119], v2, s[24:27], s9 offen offset:1024 sc1
  ds_read_b128 v[120:123], v2 offset:0
  ds_read_b128 v[124:127], v2 offset:28672
  ds_read_b128 v[128:131], v2 offset:1024
  ds_read_b128 v[132:135], v2 offset:29696
  ds_read_b128 v[244:247], v2 offset:2048
  ds_read_b128 v[248:251], v2 offset:30720
  s_waitcnt vmcnt(28)
  s_waitcnt vmcnt(27)
  s_waitcnt lgkmcnt(4)
  v_mfma_f32_32x32x16_bf16 v[152:167], v[120:123], v[8:11], 0
  ds_read_b128 v[252:255], v2 offset:3072
  v_add_f32 v200, v200, v202
  v_add_f32 v201, v201, v203
  v_mfma_f32_32x32x16_bf16 v[168:183], v[124:127], v[8:11], 0
  ds_read_b128 v[120:123], v2 offset:31744
  v_add_f32 v200, v200, v204
  v_add_f32 v201, v201, v205
  s_waitcnt vmcnt(26)
  s_waitcnt lgkmcnt(4)
  v_mfma_f32_32x32x16_bf16 v[152:167], v[128:131], v[12:15], v[152:167]
  ds_read_b128 v[124:127], v2 offset:4096
  v_add_f32 v200, v200, v206
  v_add_f32 v201, v201, v207
  v_mfma_f32_32x32x16_bf16 v[168:183], v[132:135], v[12:15], v[168:183]
  ds_read_b128 v[128:131], v2 offset:32768
  v_add_f32 v200, v200, v208
  v_add_f32 v201, v201, v209
  s_waitcnt vmcnt(25)
  s_waitcnt lgkmcnt(4)
  v_mfma_f32_32x32x16_bf16 v[152:167], v[244:247], v[16:19], v[152:167]
  ds_read_b128 v[132:135], v2 offset:5120
  v_add_f32 v200, v200, v210
  v_add_f32 v201, v201, v211
  v_mfma_f32_32x32x16_bf16 v[168:183], v[248:251], v[16:19], v[168:183]
  ds_read_b128 v[244:247], v2 offset:33792
  v_add_f32 v200, v200, v212
  v_add_f32 v201, v201, v213
  s_waitcnt vmcnt(24)
  s_waitcnt lgkmcnt(4)
  v_mfma_f32_32x32x16_bf16 v[152:167], v[252:255], v[20:23], v[152:167]
  ds_read_b128 v[248:251], v2 offset:6144
  v_mov_b32 v232, v200
  v_mov_b32 v233, v201
  v_mfma_f32_32x32x16_bf16 v[168:183], v[120:123], v[20:23], v[168:183]
  ds_read_b128 v[252:255], v2 offset:34816
  s_nop 0
  v_permlane32_swap_b32 v232, v200
  s_waitcnt vmcnt(23)
  s_waitcnt lgkmcnt(4)
  v_mfma_f32_32x32x16_bf16 v[152:167], v[124:127], v[24:27], v[152:167]
  ds_read_b128 v[120:123], v2 offset:7168
  v_permlane32_swap_b32 v233, v201
  v_add_f32 v200, v200, v232
  v_mfma_f32_32x32x16_bf16 v[168:183], v[128:131], v[24:27], v[168:183]
  ds_read_b128 v[124:127], v2 offset:35840
  v_add_f32 v201, v201, v233
  v_mul_f32 v200, 0xbb124925, v200
  s_waitcnt vmcnt(22)
  s_waitcnt lgkmcnt(4)
  v_mfma_f32_32x32x16_bf16 v[152:167], v[132:135], v[28:31], v[152:167]
  ds_read_b128 v[128:131], v2 offset:8192
  v_mul_f32 v201, 0x3b124925, v201
  v_fma_f32 v201, -v200, v200, v201
  v_mfma_f32_32x32x16_bf16 v[168:183], v[244:247], v[28:31], v[168:183]
  ds_read_b128 v[132:135], v2 offset:36864
  v_max_f32 v201, 0, v201
  v_add_f32 v234, 0x3727c5ac, v201
  s_waitcnt vmcnt(21)
  s_waitcnt lgkmcnt(4)
  v_mfma_f32_32x32x16_bf16 v[152:167], v[248:251], v[32:35], v[152:167]
  ds_read_b128 v[244:247], v2 offset:9216
  v_rsq_f32 v201, v234
  v_sqrt_f32 v228, v234
  v_mfma_f32_32x32x16_bf16 v[168:183], v[252:255], v[32:35], v[168:183]
  ds_read_b128 v[248:251], v2 offset:37888
  v_mul_f32 v229, 0xbfb8aa3b, v201
  v_mul_f32 v200, v200, v230
  s_waitcnt vmcnt(20)
  s_waitcnt lgkmcnt(4)
  v_mfma_f32_32x32x16_bf16 v[152:167], v[120:123], v[36:39], v[152:167]
  ds_read_b128 v[252:255], v2 offset:10240
  v_and_b32 v232, 0xffff0000, v200
  v_sub_f32 v233, v200, v232
  v_mfma_f32_32x32x16_bf16 v[168:183], v[124:127], v[36:39], v[168:183]
  ds_read_b128 v[120:123], v2 offset:38912
  v_cvt_pk_bf16_f32 v224, v232, v232
  v_cvt_pk_bf16_f32 v225, v233, 0
  s_waitcnt vmcnt(19)
  s_waitcnt lgkmcnt(4)
  v_mfma_f32_32x32x16_bf16 v[152:167], v[128:131], v[40:43], v[152:167]
  ds_read_b128 v[124:127], v2 offset:11264
  v_mov_b32 v138, 0
  v_mov_b32 v139, 0
  v_mfma_f32_32x32x16_bf16 v[168:183], v[132:135], v[40:43], v[168:183]
  ds_read_b128 v[128:131], v2 offset:39936
  v_mov_b32 v142, 0
  v_mov_b32 v143, 0
  s_waitcnt vmcnt(18)
  s_waitcnt lgkmcnt(4)
  v_mfma_f32_32x32x16_bf16 v[152:167], v[244:247], v[44:47], v[152:167]
  ds_read_b128 v[132:135], v2 offset:12288
  v_mov_b32 v146, 0
  v_mov_b32 v147, 0
  v_mfma_f32_32x32x16_bf16 v[168:183], v[248:251], v[44:47], v[168:183]
  ds_read_b128 v[244:247], v2 offset:40960
  v_mov_b32 v150, 0
  v_mov_b32 v151, 0
  s_waitcnt vmcnt(17)
  s_waitcnt lgkmcnt(4)
  v_mfma_f32_32x32x16_bf16 v[152:167], v[252:255], v[48:51], v[152:167]
  ds_read_b128 v[248:251], v2 offset:13312
  v_and_b32 v234, 0xffff0000, v236
  v_sub_f32 v235, v236, v234
  v_mfma_f32_32x32x16_bf16 v[168:183], v[120:123], v[48:51], v[168:183]
  ds_read_b128 v[252:255], v2 offset:41984
  v_cvt_pk_bf16_f32 v136, v234, v235
  v_lshrrev_b32 v137, 16, v234
  s_waitcnt vmcnt(16)
  s_waitcnt lgkmcnt(4)
  v_mfma_f32_32x32x16_bf16 v[152:167], v[124:127], v[52:55], v[152:167]
  ds_read_b128 v[120:123], v2 offset:14336
  v_and_b32 v234, 0xffff0000, v237
  v_sub_f32 v235, v237, v234
  v_mfma_f32_32x32x16_bf16 v[168:183], v[128:131], v[52:55], v[168:183]
  ds_read_b128 v[124:127], v2 offset:43008
  v_cvt_pk_bf16_f32 v140, v234, v235
  v_lshrrev_b32 v141, 16, v234
  s_waitcnt vmcnt(15)
  s_waitcnt lgkmcnt(4)
  v_mfma_f32_32x32x16_bf16 v[152:167], v[132:135], v[56:59], v[152:167]
  ds_read_b128 v[128:131], v2 offset:15360
  v_and_b32 v234, 0xffff0000, v238
  v_sub_f32 v235, v238, v234
  v_mfma_f32_32x32x16_bf16 v[168:183], v[244:247], v[56:59], v[168:183]
  ds_read_b128 v[132:135], v2 offset:44032
  v_cvt_pk_bf16_f32 v144, v234, v235
  v_lshrrev_b32 v145, 16, v234
  s_waitcnt vmcnt(14)
  s_waitcnt lgkmcnt(4)
  v_mfma_f32_32x32x16_bf16 v[152:167], v[248:251], v[60:63], v[152:167]
  ds_read_b128 v[244:247], v2 offset:16384
  v_and_b32 v234, 0xffff0000, v239
  v_sub_f32 v235, v239, v234
  v_mfma_f32_32x32x16_bf16 v[168:183], v[252:255], v[60:63], v[168:183]
  ds_read_b128 v[248:251], v2 offset:45056
  v_cvt_pk_bf16_f32 v148, v234, v235
  v_lshrrev_b32 v149, 16, v234
  s_waitcnt vmcnt(13)
  s_waitcnt lgkmcnt(4)
  v_mfma_f32_32x32x16_bf16 v[152:167], v[120:123], v[64:67], v[152:167]
  ds_read_b128 v[252:255], v2 offset:17408
  v_mfma_f32_32x32x16_bf16 v[168:183], v[124:127], v[64:67], v[168:183]
  ds_read_b128 v[120:123], v2 offset:46080
  s_waitcnt vmcnt(12)
  s_waitcnt lgkmcnt(4)
  v_mfma_f32_32x32x16_bf16 v[152:167], v[128:131], v[68:71], v[152:167]
  ds_read_b128 v[124:127], v2 offset:18432
  v_mfma_f32_32x32x16_bf16 v[168:183], v[132:135], v[68:71], v[168:183]
  ds_read_b128 v[128:131], v2 offset:47104
  s_waitcnt vmcnt(11)
  s_waitcnt lgkmcnt(4)
  v_mfma_f32_32x32x16_bf16 v[152:167], v[244:247], v[72:75], v[152:167]
  ds_read_b128 v[132:135], v2 offset:19456
  v_mfma_f32_32x32x16_bf16 v[168:183], v[248:251], v[72:75], v[168:183]
  ds_read_b128 v[244:247], v2 offset:48128
  s_waitcnt vmcnt(10)
  s_waitcnt lgkmcnt(4)
  v_mfma_f32_32x32x16_bf16 v[152:167], v[252:255], v[76:79], v[152:167]
  ds_read_b128 v[248:251], v2 offset:20480
  v_mfma_f32_32x32x16_bf16 v[168:183], v[120:123], v[76:79], v[168:183]
  ds_read_b128 v[252:255], v2 offset:49152
  s_waitcnt vmcnt(9)
  s_waitcnt lgkmcnt(4)
  v_mfma_f32_32x32x16_bf16 v[152:167], v[124:127], v[80:83], v[152:167]
  ds_read_b128 v[120:123], v2 offset:21504
  v_mfma_f32_32x32x16_bf16 v[168:183], v[128:131], v[80:83], v[168:183]
  ds_read_b128 v[124:127], v2 offset:50176
  s_waitcnt vmcnt(8)
  s_waitcnt lgkmcnt(4)
  v_mfma_f32_32x32x16_bf16 v[152:167], v[132:135], v[84:87], v[152:167]
  ds_read_b128 v[128:131], v2 offset:22528
  v_mfma_f32_32x32x16_bf16 v[168:183], v[244:247], v[84:87], v[168:183]
  ds_read_b128 v[132:135], v2 offset:51200
  s_waitcnt vmcnt(7)
  s_waitcnt lgkmcnt(4)
  v_mfma_f32_32x32x16_bf16 v[152:167], v[248:251], v[88:91], v[152:167]
  ds_read_b128 v[244:247], v2 offset:23552
  v_mfma_f32_32x32x16_bf16 v[168:183], v[252:255], v[88:91], v[168:183]
  ds_read_b128 v[248:251], v2 offset:52224
  s_waitcnt vmcnt(6)
  s_waitcnt lgkmcnt(4)
  v_mfma_f32_32x32x16_bf16 v[152:167], v[120:123], v[92:95], v[152:167]
  ds_read_b128 v[252:255], v2 offset:24576
  v_mfma_f32_32x32x16_bf16 v[168:183], v[124:127], v[92:95], v[168:183]
  ds_read_b128 v[120:123], v2 offset:53248
  s_waitcnt vmcnt(5)
  s_waitcnt lgkmcnt(4)
  v_mfma_f32_32x32x16_bf16 v[152:167], v[128:131], v[96:99], v[152:167]
  ds_read_b128 v[124:127], v2 offset:25600
  v_mfma_f32_32x32x16_bf16 v[168:183], v[132:135], v[96:99], v[168:183]
  ds_read_b128 v[128:131], v2 offset:54272
  s_waitcnt vmcnt(4)
  s_waitcnt lgkmcnt(4)
  v_mfma_f32_32x32x16_bf16 v[152:167], v[244:247], v[100:103], v[152:167]
  ds_read_b128 v[132:135], v2 offset:26624
  v_mfma_f32_32x32x16_bf16 v[168:183], v[248:251], v[100:103], v[168:183]
  ds_read_b128 v[244:247], v2 offset:55296
  s_waitcnt vmcnt(3)
  s_waitcnt lgkmcnt(4)
  v_mfma_f32_32x32x16_bf16 v[152:167], v[252:255], v[104:107], v[152:167]
  ds_read_b128 v[248:251], v2 offset:27648
  v_mfma_f32_32x32x16_bf16 v[168:183], v[120:123], v[104:107], v[168:183]
  ds_read_b128 v[252:255], v2 offset:56320
  s_waitcnt vmcnt(2)
  s_waitcnt lgkmcnt(4)
  v_mfma_f32_32x32x16_bf16 v[152:167], v[124:127], v[108:111], v[152:167]
  ds_read_b128 v[120:123], v2 offset:57344
  v_mfma_f32_32x32x16_bf16 v[168:183], v[128:131], v[108:111], v[168:183]
  ds_read_b128 v[124:127], v2 offset:58368
  s_waitcnt vmcnt(1)
  s_waitcnt lgkmcnt(4)
  v_mfma_f32_32x32x16_bf16 v[152:167], v[132:135], v[112:115], v[152:167]
  ds_read_b128 v[128:131], v2 offset:59392
  v_mfma_f32_32x32x16_bf16 v[168:183], v[244:247], v[112:115], v[168:183]
  ds_read_b128 v[132:135], v2 offset:60416
  s_waitcnt vmcnt(0)
  s_waitcnt lgkmcnt(4)
  v_mfma_f32_32x32x16_bf16 v[152:167], v[248:251], v[116:119], v[152:167]
  ds_read_b128 v[244:247], v2 offset:61440
  v_mfma_f32_32x32x16_bf16 v[168:183], v[252:255], v[116:119], v[168:183]
  ds_read_b128 v[248:251], v2 offset:62464
  v_mfma_f32_32x32x16_bf16 v[152:167], v[136:139], v[224:227], v[152:167]
  v_mfma_f32_32x32x16_bf16 v[168:183], v[140:143], v[224:227], v[168:183]
  v_mfma_f32_32x32x16_bf16 v[184:199], v[144:147], v[224:227], 0
  s_waitcnt lgkmcnt(4)
  v_mfma_f32_32x32x16_bf16 v[184:199], v[120:123], v[8:11], v[184:199]
  ds_read_b128 v[252:255], v2 offset:63488
  v_mfma_f32_32x32x16_bf16 v[184:199], v[124:127], v[12:15], v[184:199]
  ds_read_b128 v[120:123], v2 offset:64512
  s_nop 4
  v_mul_f32 v232, v152, v229
  v_mul_f32 v233, v153, v229
  v_mul_f32 v234, v154, v229
  v_mul_f32 v235, v155, v229
  v_exp_f32 v232, v232
  s_waitcnt lgkmcnt(4)
  v_mfma_f32_32x32x16_bf16 v[184:199], v[128:131], v[16:19], v[184:199]
  ds_read_b128 v[124:127], v3 offset:0
  v_exp_f32 v233, v233
  v_exp_f32 v234, v234
  v_exp_f32 v235, v235
  v_fma_f32 v232, v232, v228, v228
  v_fma_f32 v233, v233, v228, v228
  v_mfma_f32_32x32x16_bf16 v[184:199], v[132:135], v[20:23], v[184:199]
  ds_read_b128 v[128:131], v3 offset:1024
  v_fma_f32 v234, v234, v228, v228
  v_fma_f32 v235, v235, v228, v228
  v_rcp_f32 v232, v232
  v_rcp_f32 v233, v233
  v_rcp_f32 v234, v234
  s_waitcnt lgkmcnt(4)
  v_mfma_f32_32x32x16_bf16 v[184:199], v[244:247], v[24:27], v[184:199]
  ds_read_b128 v[132:135], v3 offset:2048
  v_rcp_f32 v235, v235
  v_mul_f32 v152, v152, v232
  v_mul_f32 v153, v153, v233
  v_mul_f32 v154, v154, v234
  v_mul_f32 v155, v155, v235
  v_mfma_f32_32x32x16_bf16 v[184:199], v[248:251], v[28:31], v[184:199]
  ds_read_b128 v[244:247], v3 offset:3072
  v_cvt_pk_bf16_f32 v152, v152, v153
  v_cvt_pk_bf16_f32 v153, v154, v155
  v_mul_f32 v232, v156, v229
  v_mul_f32 v233, v157, v229
  v_mul_f32 v234, v158, v229
  s_waitcnt lgkmcnt(4)
  v_mfma_f32_32x32x16_bf16 v[184:199], v[252:255], v[32:35], v[184:199]
  ds_read_b128 v[248:251], v3 offset:4096
  v_mul_f32 v235, v159, v229
  v_exp_f32 v232, v232
  v_exp_f32 v233, v233
  v_exp_f32 v234, v234
  v_exp_f32 v235, v235
  v_mfma_f32_32x32x16_bf16 v[184:199], v[120:123], v[36:39], v[184:199]
  ds_read_b128 v[252:255], v3 offset:5120
  v_fma_f32 v232, v232, v228, v228
  v_fma_f32 v233, v233, v228, v228
  v_fma_f32 v234, v234, v228, v228
  v_fma_f32 v235, v235, v228, v228
  v_rcp_f32 v232, v232
  s_waitcnt lgkmcnt(4)
  v_mfma_f32_32x32x16_bf16 v[184:199], v[124:127], v[40:43], v[184:199]
  ds_read_b128 v[120:123], v3 offset:6144
  v_rcp_f32 v233, v233
  v_rcp_f32 v234, v234
  v_rcp_f32 v235, v235
  v_mul_f32 v156, v156, v232
  v_mul_f32 v157, v157, v233
  v_mfma_f32_32x32x16_bf16 v[184:199], v[128:131], v[44:47], v[184:199]
  ds_read_b128 v[124:127], v3 offset:7168
  v_mul_f32 v158, v158, v234
  v_mul_f32 v159, v159, v235
  v_cvt_pk_bf16_f32 v154, v156, v157
  v_cvt_pk_bf16_f32 v155, v158, v159
  buffer_store_dwordx4 v[152:155], v2, s[24:27], s58 offen offset:0 sc1
  s_waitcnt lgkmcnt(4)
  v_mfma_f32_32x32x16_bf16 v[184:199], v[132:135], v[48:51], v[184:199]
  ds_read_b128 v[128:131], v3 offset:8192
  v_mul_f32 v232, v160, v229
  v_mul_f32 v233, v161, v229
  v_mul_f32 v234, v162, v229
  v_mul_f32 v235, v163, v229
  v_exp_f32 v232, v232
  v_mfma_f32_32x32x16_bf16 v[184:199], v[244:247], v[52:55], v[184:199]
  ds_read_b128 v[132:135], v3 offset:9216
  v_exp_f32 v233, v233
  v_exp_f32 v234, v234
  v_exp_f32 v235, v235
  v_fma_f32 v232, v232, v228, v228
  v_fma_f32 v233, v233, v228, v228
  s_waitcnt lgkmcnt(4)
  v_mfma_f32_32x32x16_bf16 v[184:199], v[248:251], v[56:59], v[184:199]
  ds_read_b128 v[244:247], v3 offset:10240
  v_fma_f32 v234, v234, v228, v228
  v_fma_f32 v235, v235, v228, v228
  v_rcp_f32 v232, v232
  v_rcp_f32 v233, v233
  v_rcp_f32 v234, v234
  v_mfma_f32_32x32x16_bf16 v[184:199], v[252:255], v[60:63], v[184:199]
  ds_read_b128 v[248:251], v3 offset:11264
  v_rcp_f32 v235, v235
  v_mul_f32 v160, v160, v232
  v_mul_f32 v161, v161, v233
  v_mul_f32 v162, v162, v234
  v_mul_f32 v163, v163, v235
  s_waitcnt lgkmcnt(4)
  v_mfma_f32_32x32x16_bf16 v[184:199], v[120:123], v[64:67], v[184:199]
  ds_read_b128 v[252:255], v3 offset:12288
  v_cvt_pk_bf16_f32 v156, v160, v161
  v_cvt_pk_bf16_f32 v157, v162, v163
  v_mul_f32 v232, v164, v229
  v_mul_f32 v233, v165, v229
  v_mul_f32 v234, v166, v229
  v_mfma_f32_32x32x16_bf16 v[184:199], v[124:127], v[68:71], v[184:199]
  ds_read_b128 v[120:123], v3 offset:13312
  v_mul_f32 v235, v167, v229
  v_exp_f32 v232, v232
  v_exp_f32 v233, v233
  v_exp_f32 v234, v234
  v_exp_f32 v235, v235
  s_waitcnt lgkmcnt(4)
  v_mfma_f32_32x32x16_bf16 v[184:199], v[128:131], v[72:75], v[184:199]
  ds_read_b128 v[124:127], v3 offset:14336
  v_fma_f32 v232, v232, v228, v228
  v_fma_f32 v233, v233, v228, v228
  v_fma_f32 v234, v234, v228, v228
  v_fma_f32 v235, v235, v228, v228
  v_rcp_f32 v232, v232
  v_mfma_f32_32x32x16_bf16 v[184:199], v[132:135], v[76:79], v[184:199]
  ds_read_b128 v[128:131], v3 offset:15360
  v_rcp_f32 v233, v233
  v_rcp_f32 v234, v234
  v_rcp_f32 v235, v235
  v_mul_f32 v164, v164, v232
  v_mul_f32 v165, v165, v233
  s_waitcnt lgkmcnt(4)
  v_mfma_f32_32x32x16_bf16 v[184:199], v[244:247], v[80:83], v[184:199]
  ds_read_b128 v[132:135], v3 offset:16384
  v_mul_f32 v166, v166, v234
  v_mul_f32 v167, v167, v235
  v_cvt_pk_bf16_f32 v158, v164, v165
  v_cvt_pk_bf16_f32 v159, v166, v167
  buffer_store_dwordx4 v[156:159], v2, s[24:27], s58 offen offset:1024 sc1
  v_mfma_f32_32x32x16_bf16 v[184:199], v[248:251], v[84:87], v[184:199]
  ds_read_b128 v[244:247], v3 offset:17408
  v_mul_f32 v232, v168, v229
  v_mul_f32 v233, v169, v229
  v_mul_f32 v234, v170, v229
  v_mul_f32 v235, v171, v229
  v_exp_f32 v232, v232
  s_waitcnt lgkmcnt(4)
  v_mfma_f32_32x32x16_bf16 v[184:199], v[252:255], v[88:91], v[184:199]
  ds_read_b128 v[248:251], v3 offset:18432
  v_exp_f32 v233, v233
  v_exp_f32 v234, v234
  v_exp_f32 v235, v235
  v_fma_f32 v232, v232, v228, v228
  v_fma_f32 v233, v233, v228, v228
  v_mfma_f32_32x32x16_bf16 v[184:199], v[120:123], v[92:95], v[184:199]
  ds_read_b128 v[252:255], v3 offset:19456
  v_fma_f32 v234, v234, v228, v228
  v_fma_f32 v235, v235, v228, v228
  v_rcp_f32 v232, v232
  v_rcp_f32 v233, v233
  v_rcp_f32 v234, v234
  s_waitcnt lgkmcnt(4)
  v_mfma_f32_32x32x16_bf16 v[184:199], v[124:127], v[96:99], v[184:199]
  ds_read_b128 v[120:123], v3 offset:20480
  v_rcp_f32 v235, v235
  v_mul_f32 v168, v168, v232
  v_mul_f32 v169, v169, v233
  v_mul_f32 v170, v170, v234
  v_mul_f32 v171, v171, v235
  v_mfma_f32_32x32x16_bf16 v[184:199], v[128:131], v[100:103], v[184:199]
  ds_read_b128 v[124:127], v3 offset:21504
  v_cvt_pk_bf16_f32 v168, v168, v169
  v_cvt_pk_bf16_f32 v169, v170, v171
  v_mul_f32 v232, v172, v229
  v_mul_f32 v233, v173, v229
  v_mul_f32 v234, v174, v229
  s_waitcnt lgkmcnt(4)
  v_mfma_f32_32x32x16_bf16 v[184:199], v[132:135], v[104:107], v[184:199]
  ds_read_b128 v[128:131], v3 offset:22528
  v_mul_f32 v235, v175, v229
  v_exp_f32 v232, v232
  v_exp_f32 v233, v233
  v_exp_f32 v234, v234
  v_exp_f32 v235, v235
  v_mfma_f32_32x32x16_bf16 v[184:199], v[244:247], v[108:111], v[184:199]
  ds_read_b128 v[132:135], v3 offset:23552
  v_fma_f32 v232, v232, v228, v228
  v_fma_f32 v233, v233, v228, v228
  v_fma_f32 v234, v234, v228, v228
  v_fma_f32 v235, v235, v228, v228
  v_rcp_f32 v232, v232
  s_waitcnt lgkmcnt(4)
  v_mfma_f32_32x32x16_bf16 v[184:199], v[248:251], v[112:115], v[184:199]
  ds_read_b128 v[244:247], v3 offset:24576
  v_rcp_f32 v233, v233
  v_rcp_f32 v234, v234
  v_rcp_f32 v235, v235
  v_mul_f32 v172, v172, v232
  v_mul_f32 v173, v173, v233
  v_mfma_f32_32x32x16_bf16 v[184:199], v[252:255], v[116:119], v[184:199]
  ds_read_b128 v[248:251], v3 offset:25600
  v_mul_f32 v174, v174, v234
  v_mul_f32 v175, v175, v235
  v_cvt_pk_bf16_f32 v170, v172, v173
  v_cvt_pk_bf16_f32 v171, v174, v175
  buffer_store_dwordx4 v[168:171], v2, s[24:27], s58 offen offset:2048 sc1
  v_mfma_f32_32x32x16_bf16 v[200:215], v[148:151], v[224:227], 0
  s_waitcnt lgkmcnt(4)
  v_mfma_f32_32x32x16_bf16 v[200:215], v[120:123], v[8:11], v[200:215]
  ds_read_b128 v[252:255], v3 offset:26624
  v_mul_f32 v232, v176, v229
  v_mul_f32 v233, v177, v229
  v_mul_f32 v234, v178, v229
  v_mul_f32 v235, v179, v229
  v_exp_f32 v232, v232
  v_mfma_f32_32x32x16_bf16 v[200:215], v[124:127], v[12:15], v[200:215]
  ds_read_b128 v[120:123], v3 offset:27648
  v_exp_f32 v233, v233
  v_exp_f32 v234, v234
  v_exp_f32 v235, v235
  v_fma_f32 v232, v232, v228, v228
  v_fma_f32 v233, v233, v228, v228
  s_waitcnt lgkmcnt(4)
  v_mfma_f32_32x32x16_bf16 v[200:215], v[128:131], v[16:19], v[200:215]
  ds_read_b128 v[124:127], v3 offset:28672
  v_fma_f32 v234, v234, v228, v228
  v_fma_f32 v235, v235, v228, v228
  v_rcp_f32 v232, v232
  v_rcp_f32 v233, v233
  v_rcp_f32 v234, v234
  v_mfma_f32_32x32x16_bf16 v[200:215], v[132:135], v[20:23], v[200:215]
  ds_read_b128 v[128:131], v3 offset:29696
  v_rcp_f32 v235, v235
  v_mul_f32 v176, v176, v232
  v_mul_f32 v177, v177, v233
  v_mul_f32 v178, v178, v234
  v_mul_f32 v179, v179, v235
  s_waitcnt lgkmcnt(4)
  v_mfma_f32_32x32x16_bf16 v[200:215], v[244:247], v[24:27], v[200:215]
  ds_read_b128 v[132:135], v3 offset:30720
  v_cvt_pk_bf16_f32 v172, v176, v177
  v_cvt_pk_bf16_f32 v173, v178, v179
  v_mul_f32 v232, v180, v229
  v_mul_f32 v233, v181, v229
  v_mul_f32 v234, v182, v229
  v_mfma_f32_32x32x16_bf16 v[200:215], v[248:251], v[28:31], v[200:215]
  ds_read_b128 v[244:247], v3 offset:31744
  v_mul_f32 v235, v183, v229
  v_exp_f32 v232, v232
  v_exp_f32 v233, v233
  v_exp_f32 v234, v234
  v_exp_f32 v235, v235
  s_waitcnt lgkmcnt(4)
  v_mfma_f32_32x32x16_bf16 v[200:215], v[252:255], v[32:35], v[200:215]
  ds_read_b128 v[248:251], v3 offset:32768
  v_fma_f32 v232, v232, v228, v228
  v_fma_f32 v233, v233, v228, v228
  v_fma_f32 v234, v234, v228, v228
  v_fma_f32 v235, v235, v228, v228
  v_rcp_f32 v232, v232
  v_mfma_f32_32x32x16_bf16 v[200:215], v[120:123], v[36:39], v[200:215]
  ds_read_b128 v[252:255], v3 offset:33792
  v_rcp_f32 v233, v233
  v_rcp_f32 v234, v234
  v_rcp_f32 v235, v235
  v_mul_f32 v180, v180, v232
  v_mul_f32 v181, v181, v233
  s_waitcnt lgkmcnt(4)
  v_mfma_f32_32x32x16_bf16 v[200:215], v[124:127], v[40:43], v[200:215]
  ds_read_b128 v[120:123], v3 offset:34816
  v_mul_f32 v182, v182, v234
  v_mul_f32 v183, v183, v235
  v_cvt_pk_bf16_f32 v174, v180, v181
  v_cvt_pk_bf16_f32 v175, v182, v183
  buffer_store_dwordx4 v[172:175], v2, s[24:27], s58 offen offset:3072 sc1
  v_mfma_f32_32x32x16_bf16 v[200:215], v[128:131], v[44:47], v[200:215]
  ds_read_b128 v[124:127], v3 offset:35840
  v_mul_f32 v232, v184, v229
  v_mul_f32 v233, v185, v229
  v_mul_f32 v234, v186, v229
  v_mul_f32 v235, v187, v229
  v_exp_f32 v232, v232
  s_waitcnt lgkmcnt(4)
  v_mfma_f32_32x32x16_bf16 v[200:215], v[132:135], v[48:51], v[200:215]
  ds_read_b128 v[128:131], v3 offset:36864
  v_exp_f32 v233, v233
  v_exp_f32 v234, v234
  v_exp_f32 v235, v235
  v_fma_f32 v232, v232, v228, v228
  v_fma_f32 v233, v233, v228, v228
  v_mfma_f32_32x32x16_bf16 v[200:215], v[244:247], v[52:55], v[200:215]
  ds_read_b128 v[132:135], v3 offset:37888
  v_fma_f32 v234, v234, v228, v228
  v_fma_f32 v235, v235, v228, v228
  v_rcp_f32 v232, v232
  v_rcp_f32 v233, v233
  v_rcp_f32 v234, v234
  s_waitcnt lgkmcnt(4)
  v_mfma_f32_32x32x16_bf16 v[200:215], v[248:251], v[56:59], v[200:215]
  ds_read_b128 v[244:247], v3 offset:38912
  v_rcp_f32 v235, v235
  v_mul_f32 v184, v184, v232
  v_mul_f32 v185, v185, v233
  v_mul_f32 v186, v186, v234
  v_mul_f32 v187, v187, v235
  v_mfma_f32_32x32x16_bf16 v[200:215], v[252:255], v[60:63], v[200:215]
  ds_read_b128 v[248:251], v3 offset:39936
  v_cvt_pk_bf16_f32 v184, v184, v185
  v_cvt_pk_bf16_f32 v185, v186, v187
  v_mul_f32 v232, v188, v229
  v_mul_f32 v233, v189, v229
  v_mul_f32 v234, v190, v229
  s_waitcnt lgkmcnt(4)
  v_mfma_f32_32x32x16_bf16 v[200:215], v[120:123], v[64:67], v[200:215]
  ds_read_b128 v[252:255], v3 offset:40960
  v_mul_f32 v235, v191, v229
  v_exp_f32 v232, v232
  v_exp_f32 v233, v233
  v_exp_f32 v234, v234
  v_exp_f32 v235, v235
  v_mfma_f32_32x32x16_bf16 v[200:215], v[124:127], v[68:71], v[200:215]
  ds_read_b128 v[120:123], v3 offset:41984
  v_fma_f32 v232, v232, v228, v228
  v_fma_f32 v233, v233, v228, v228
  v_fma_f32 v234, v234, v228, v228
  v_fma_f32 v235, v235, v228, v228
  v_rcp_f32 v232, v232
  s_waitcnt lgkmcnt(4)
  v_mfma_f32_32x32x16_bf16 v[200:215], v[128:131], v[72:75], v[200:215]
  ds_read_b128 v[124:127], v3 offset:43008
  v_rcp_f32 v233, v233
  v_rcp_f32 v234, v234
  v_rcp_f32 v235, v235
  v_mul_f32 v188, v188, v232
  v_mul_f32 v189, v189, v233
  v_mfma_f32_32x32x16_bf16 v[200:215], v[132:135], v[76:79], v[200:215]
  ds_read_b128 v[128:131], v3 offset:44032
  v_mul_f32 v190, v190, v234
  v_mul_f32 v191, v191, v235
  v_cvt_pk_bf16_f32 v186, v188, v189
  v_cvt_pk_bf16_f32 v187, v190, v191
  buffer_store_dwordx4 v[184:187], v2, s[24:27], s59 offen offset:0 sc1
  s_waitcnt lgkmcnt(4)
  v_mfma_f32_32x32x16_bf16 v[200:215], v[244:247], v[80:83], v[200:215]
  ds_read_b128 v[132:135], v3 offset:45056
  v_mul_f32 v232, v192, v229
  v_mul_f32 v233, v193, v229
  v_mul_f32 v234, v194, v229
  v_mul_f32 v235, v195, v229
  v_exp_f32 v232, v232
  v_mfma_f32_32x32x16_bf16 v[200:215], v[248:251], v[84:87], v[200:215]
  ds_read_b128 v[244:247], v3 offset:46080
  v_exp_f32 v233, v233
  v_exp_f32 v234, v234
  v_exp_f32 v235, v235
  v_fma_f32 v232, v232, v228, v228
  v_fma_f32 v233, v233, v228, v228
  s_waitcnt lgkmcnt(4)
  v_mfma_f32_32x32x16_bf16 v[200:215], v[252:255], v[88:91], v[200:215]
  ds_read_b128 v[248:251], v3 offset:47104
  v_fma_f32 v234, v234, v228, v228
  v_fma_f32 v235, v235, v228, v228
  v_rcp_f32 v232, v232
  v_rcp_f32 v233, v233
  v_rcp_f32 v234, v234
  v_mfma_f32_32x32x16_bf16 v[200:215], v[120:123], v[92:95], v[200:215]
  ds_read_b128 v[252:255], v3 offset:48128
  v_rcp_f32 v235, v235
  v_mul_f32 v192, v192, v232
  v_mul_f32 v193, v193, v233
  v_mul_f32 v194, v194, v234
  v_mul_f32 v195, v195, v235
  s_waitcnt lgkmcnt(4)
  v_mfma_f32_32x32x16_bf16 v[200:215], v[124:127], v[96:99], v[200:215]
  v_cvt_pk_bf16_f32 v188, v192, v193
  v_cvt_pk_bf16_f32 v189, v194, v195
  v_mul_f32 v232, v196, v229
  v_mul_f32 v233, v197, v229
  v_mul_f32 v234, v198, v229
  v_mfma_f32_32x32x16_bf16 v[200:215], v[128:131], v[100:103], v[200:215]
  v_mul_f32 v235, v199, v229
  v_exp_f32 v232, v232
  v_exp_f32 v233, v233
  v_exp_f32 v234, v234
  v_exp_f32 v235, v235
  s_waitcnt lgkmcnt(2)
  v_mfma_f32_32x32x16_bf16 v[200:215], v[132:135], v[104:107], v[200:215]
  v_fma_f32 v232, v232, v228, v228
  v_fma_f32 v233, v233, v228, v228
  v_fma_f32 v234, v234, v228, v228
  v_fma_f32 v235, v235, v228, v228
  v_rcp_f32 v232, v232
  v_mfma_f32_32x32x16_bf16 v[200:215], v[244:247], v[108:111], v[200:215]
  v_rcp_f32 v233, v233
  v_rcp_f32 v234, v234
  v_rcp_f32 v235, v235
  v_mul_f32 v196, v196, v232
  v_mul_f32 v197, v197, v233
  s_waitcnt lgkmcnt(0)
  v_mfma_f32_32x32x16_bf16 v[200:215], v[248:251], v[112:115], v[200:215]
  v_mul_f32 v198, v198, v234
  v_mul_f32 v199, v199, v235
  v_cvt_pk_bf16_f32 v190, v196, v197
  v_cvt_pk_bf16_f32 v191, v198, v199
  buffer_store_dwordx4 v[188:191], v2, s[24:27], s59 offen offset:1024 sc1
  s_waitcnt vmcnt(2)
  s_barrier
  s_cmp_lg_u32 s3, 0
  s_cbranch_scc1 Lpub_sequential_preLN__mha_block__dense_activation_silu__prompt_kernel_19
  s_mov_b64 exec, 0x1
  buffer_store_dwordx2 v[240:241], off, s[24:27], s60  sc1
  s_add_u32 s50, s60, 262144
  buffer_store_dwordx2 v[240:241], off, s[24:27], s50
  s_mov_b64 exec, -1
Lpub_sequential_preLN__mha_block__dense_activation_silu__prompt_kernel_19:
  v_mfma_f32_32x32x16_bf16 v[200:215], v[252:255], v[116:119], v[200:215]
  s_mul_i32 s54, s13, 114688
  s_xor_b32 s55, s13, 1
  s_mul_i32 s55, s55, 114688
  s_add_u32 s56, s14, 12320768
  s_add_u32 s54, s54, s56
  s_add_u32 s55, s55, s56
  s_mov_b32 s28, s16
  s_mov_b32 s29, s17
  s_lshl_b32 s50, s3, 12
  s_add_u32 s50, s50, 114688
  v_add_u32 v5, s50, v2
  s_lshl_b32 s10, s44, 14
  s_add_u32 s64, s54, s10
  s_add_u32 s71, s55, s10
  s_add_u32 s10, s10, 16384
  s_cmp_eq_u32 s10, 114688
  s_cselect_b32 s10, 0, s10
  s_add_u32 s65, s54, s10
  s_add_u32 s72, s55, s10
  s_add_u32 s10, s10, 16384
  s_cmp_eq_u32 s10, 114688
  s_cselect_b32 s10, 0, s10
  s_add_u32 s66, s54, s10
  s_add_u32 s73, s55, s10
  s_add_u32 s10, s10, 16384
  s_cmp_eq_u32 s10, 114688
  s_cselect_b32 s10, 0, s10
  s_add_u32 s67, s54, s10
  s_add_u32 s74, s55, s10
  s_add_u32 s10, s10, 16384
  s_cmp_eq_u32 s10, 114688
  s_cselect_b32 s10, 0, s10
  s_add_u32 s68, s54, s10
  s_add_u32 s75, s55, s10
  s_add_u32 s10, s10, 16384
  s_cmp_eq_u32 s10, 114688
  s_cselect_b32 s10, 0, s10
  s_add_u32 s69, s54, s10
  s_add_u32 s8, s55, s10
  s_add_u32 s10, s10, 16384
  s_cmp_eq_u32 s10, 114688
  s_cselect_b32 s10, 0, s10
  s_add_u32 s70, s54, s10
  s_add_u32 s9, s55, s10
  v_add_u32 v3, 4096, v2
  s_cmp_lg_u32 s3, 3
  s_cbranch_scc1 Lc3e_sequential_preLN__mha_block__dense_activation_silu__prompt_kernel_20
  s_mov_b64 exec, 0x3fff
  s_add_u32 s51, s61, 262144
  buffer_load_dwordx2 v[248:249], v7, s[24:27], s51 offen sc1
  s_mov_b64 exec, -1
Lc3e_sequential_preLN__mha_block__dense_activation_silu__prompt_kernel_20:
  v_pk_mul_f32 v[232:233], v[200:201], v[228:229] op_sel:[0,1] op_sel_hi:[1,1]
  v_pk_mul_f32 v[234:235], v[202:203], v[228:229] op_sel:[0,1] op_sel_hi:[1,1]
  v_exp_f32 v232, v232
  v_exp_f32 v233, v233
  v_exp_f32 v234, v234
  v_exp_f32 v235, v235
  v_pk_fma_f32 v[232:233], v[232:233], v[228:229], v[228:229] op_sel_hi:[1,0,0]
  v_pk_fma_f32 v[234:235], v[234:235], v[228:229], v[228:229] op_sel_hi:[1,0,0]
  v_rcp_f32 v232, v232
  v_rcp_f32 v233, v233
  v_rcp_f32 v234, v234
  v_rcp_f32 v235, v235
  v_pk_mul_f32 v[200:201], v[200:201], v[232:233]
  v_pk_mul_f32 v[202:203], v[202:203], v[234:235]
  v_cvt_pk_bf16_f32 v200, v200, v201
  v_cvt_pk_bf16_f32 v201, v202, v203
  v_pk_mul_f32 v[232:233], v[204:205], v[228:229] op_sel:[0,1] op_sel_hi:[1,1]
  v_pk_mul_f32 v[234:235], v[206:207], v[228:229] op_sel:[0,1] op_sel_hi:[1,1]
  v_exp_f32 v232, v232
  v_exp_f32 v233, v233
  v_exp_f32 v234, v234
  v_exp_f32 v235, v235
  v_pk_fma_f32 v[232:233], v[232:233], v[228:229], v[228:229] op_sel_hi:[1,0,0]
  v_pk_fma_f32 v[234:235], v[234:235], v[228:229], v[228:229] op_sel_hi:[1,0,0]
  v_rcp_f32 v232, v232
  v_rcp_f32 v233, v233
  v_rcp_f32 v234, v234
  v_rcp_f32 v235, v235
  v_pk_mul_f32 v[204:205], v[204:205], v[232:233]
  v_pk_mul_f32 v[206:207], v[206:207], v[234:235]
  v_cvt_pk_bf16_f32 v202, v204, v205
  v_cvt_pk_bf16_f32 v203, v206, v207
  buffer_store_dwordx4 v[200:203], v2, s[24:27], s59 offen offset:2048 sc1
  v_pk_mul_f32 v[232:233], v[208:209], v[228:229] op_sel:[0,1] op_sel_hi:[1,1]
  v_pk_mul_f32 v[234:235], v[210:211], v[228:229] op_sel:[0,1] op_sel_hi:[1,1]
  v_exp_f32 v232, v232
  v_exp_f32 v233, v233
  v_exp_f32 v234, v234
  v_exp_f32 v235, v235
  v_pk_fma_f32 v[232:233], v[232:233], v[228:229], v[228:229] op_sel_hi:[1,0,0]
  v_pk_fma_f32 v[234:235], v[234:235], v[228:229], v[228:229] op_sel_hi:[1,0,0]
  v_rcp_f32 v232, v232
  v_rcp_f32 v233, v233
  v_rcp_f32 v234, v234
  v_rcp_f32 v235, v235
  v_pk_mul_f32 v[208:209], v[208:209], v[232:233]
  v_pk_mul_f32 v[210:211], v[210:211], v[234:235]
  v_cvt_pk_bf16_f32 v204, v208, v209
  v_cvt_pk_bf16_f32 v205, v210, v211
  v_pk_mul_f32 v[232:233], v[212:213], v[228:229] op_sel:[0,1] op_sel_hi:[1,1]
  v_pk_mul_f32 v[234:235], v[214:215], v[228:229] op_sel:[0,1] op_sel_hi:[1,1]
  v_exp_f32 v232, v232
  v_exp_f32 v233, v233
  v_exp_f32 v234, v234
  v_exp_f32 v235, v235
  v_pk_fma_f32 v[232:233], v[232:233], v[228:229], v[228:229] op_sel_hi:[1,0,0]
  v_pk_fma_f32 v[234:235], v[234:235], v[228:229], v[228:229] op_sel_hi:[1,0,0]
  v_rcp_f32 v232, v232
  v_rcp_f32 v233, v233
  v_rcp_f32 v234, v234
  v_rcp_f32 v235, v235
  v_pk_mul_f32 v[212:213], v[212:213], v[232:233]
  v_pk_mul_f32 v[214:215], v[214:215], v[234:235]
  v_cvt_pk_bf16_f32 v206, v212, v213
  s_waitcnt vmcnt(1)
  s_barrier
  s_cmp_lg_u32 s3, 0
  s_cbranch_scc1 Lpub_sequential_preLN__mha_block__dense_activation_silu__prompt_kernel_21
  s_mov_b64 exec, 0x1
  buffer_store_dwordx2 v[240:241], off, s[24:27], s63  sc1
  s_add_u32 s50, s63, 262144
  buffer_store_dwordx2 v[240:241], off, s[24:27], s50
  s_mov_b64 exec, -1
Lpub_sequential_preLN__mha_block__dense_activation_silu__prompt_kernel_21:
  v_cvt_pk_bf16_f32 v207, v214, v215
  buffer_store_dwordx4 v[204:207], v2, s[24:27], s59 offen offset:3072 sc1
  s_cmp_lg_u32 s3, 3
  s_cbranch_scc1 Lpolls_sequential_preLN__mha_block__dense_activation_silu__prompt_kernel_24
  s_mov_b64 exec, 0x3fff
  s_mov_b32 s50, 0
  s_waitcnt vmcnt(2)
  v_cmp_ne_u64 vcc, s[40:41], v[248:249]
  s_nop 4
  s_cbranch_vccz Lpollo_sequential_preLN__mha_block__dense_activation_silu__prompt_kernel_23
Lpoll_sequential_preLN__mha_block__dense_activation_silu__prompt_kernel_22:
  s_cmp_lt_u32 s50, 6
  s_cselect_b32 s51, 262144, 0
  s_add_u32 s51, s51, s61
  buffer_load_dwordx2 v[248:249], v7, s[24:27], s51 offen sc1
  s_add_u32 s50, s50, 1
  s_waitcnt vmcnt(0)
  v_cmp_ne_u64 vcc, s[40:41], v[248:249]
  s_cmp_ge_u32 s50, 200000
  s_cbranch_scc1 Lpollo_sequential_preLN__mha_block__dense_activation_silu__prompt_kernel_23
  s_nop 2
  s_cbranch_vccnz Lpoll_sequential_preLN__mha_block__dense_activation_silu__prompt_kernel_22
Lpollo_sequential_preLN__mha_block__dense_activation_silu__prompt_kernel_23:
  s_mov_b64 exec, -1
Lpolls_sequential_preLN__mha_block__dense_activation_silu__prompt_kernel_24:
  s_barrier
  buffer_load_dwordx4 v[72:75], v2, s[24:27], s64 offen offset:0 sc1
  buffer_load_dwordx4 v[76:79], v2, s[24:27], s71 offen offset:0 sc1
  buffer_load_dwordx4 v[80:83], v2, s[24:27], s65 offen offset:0 sc1
  buffer_load_dwordx4 v[84:87], v2, s[24:27], s72 offen offset:0 sc1
  buffer_load_dwordx4 v[88:91], v2, s[24:27], s66 offen offset:0 sc1
  buffer_load_dwordx4 v[92:95], v2, s[24:27], s73 offen offset:0 sc1
  buffer_load_dwordx4 v[96:99], v2, s[24:27], s67 offen offset:0 sc1
  buffer_load_dwordx4 v[100:103], v2, s[24:27], s74 offen offset:0 sc1
  s_waitcnt vmcnt(8)
  s_barrier
  s_cmp_lg_u32 s3, 0
  s_cbranch_scc1 Lpub_sequential_preLN__mha_block__dense_activation_silu__prompt_kernel_25
  s_mov_b64 exec, 0x1
  buffer_store_dwordx2 v[240:241], off, s[24:27], s49  sc1
  s_add_u32 s50, s49, 262144
  buffer_store_dwordx2 v[240:241], off, s[24:27], s50
  s_mov_b64 exec, -1
Lpub_sequential_preLN__mha_block__dense_activation_silu__prompt_kernel_25:
  buffer_load_dwordx4 v[104:107], v2, s[24:27], s68 offen offset:0 sc1
  buffer_load_dwordx4 v[108:111], v2, s[24:27], s75 offen offset:0 sc1
  buffer_load_dwordx4 v[112:115], v2, s[24:27], s69 offen offset:0 sc1
  buffer_load_dwordx4 v[116:119], v2, s[24:27], s8 offen offset:0 sc1
  buffer_load_dwordx4 v[120:123], v2, s[24:27], s70 offen offset:0 sc1
  buffer_load_dwordx4 v[124:127], v2, s[24:27], s9 offen offset:0 sc1
  buffer_load_dwordx4 v[128:131], v2, s[24:27], s64 offen offset:2048 sc1
  buffer_load_dwordx4 v[132:135], v2, s[24:27], s71 offen offset:2048 sc1
  s_cmp_lg_u32 s3, 3
  s_cbranch_scc1 Lc3e_sequential_preLN__mha_block__dense_activation_silu__prompt_kernel_26
  s_mov_b64 exec, 0x3fff
  s_add_u32 s51, s62, 262144
  buffer_load_dwordx2 v[248:249], v7, s[24:27], s51 offen sc1
  s_mov_b64 exec, -1
Lc3e_sequential_preLN__mha_block__dense_activation_silu__prompt_kernel_26:
  buffer_load_dwordx4 v[136:139], v2, s[24:27], s65 offen offset:2048 sc1
  buffer_load_dwordx4 v[140:143], v2, s[24:27], s72 offen offset:2048 sc1
  buffer_load_dwordx4 v[144:147], v2, s[24:27], s66 offen offset:2048 sc1
  buffer_load_dwordx4 v[148:151], v2, s[24:27], s73 offen offset:2048 sc1
  buffer_load_dwordx4 v[152:155], v2, s[24:27], s67 offen offset:2048 sc1
  buffer_load_dwordx4 v[156:159], v2, s[24:27], s74 offen offset:2048 sc1
  buffer_load_dwordx4 v[160:163], v2, s[24:27], s68 offen offset:2048 sc1
  buffer_load_dwordx4 v[164:167], v2, s[24:27], s75 offen offset:2048 sc1
  buffer_load_dwordx4 v[168:171], v2, s[24:27], s69 offen offset:2048 sc1
  buffer_load_dwordx4 v[172:175], v2, s[24:27], s8 offen offset:2048 sc1
  buffer_load_dwordx4 v[176:179], v2, s[24:27], s70 offen offset:2048 sc1
  buffer_load_dwordx4 v[180:183], v2, s[24:27], s9 offen offset:2048 sc1
  v_lshlrev_b32 v184, 16, v216
  v_and_b32 v185, 0xffff0000, v216
  v_lshlrev_b32 v186, 16, v217
  v_and_b32 v187, 0xffff0000, v217
  v_lshlrev_b32 v188, 16, v218
  v_and_b32 v189, 0xffff0000, v218
  v_lshlrev_b32 v190, 16, v219
  v_and_b32 v191, 0xffff0000, v219
  v_lshlrev_b32 v192, 16, v220
  v_and_b32 v193, 0xffff0000, v220
  v_lshlrev_b32 v194, 16, v221
  v_and_b32 v195, 0xffff0000, v221
  v_lshlrev_b32 v196, 16, v222
  v_and_b32 v197, 0xffff0000, v222
  v_lshlrev_b32 v198, 16, v223
  v_and_b32 v199, 0xffff0000, v223
  s_waitcnt vmcnt(26)
  v_mfma_f32_32x32x16_bf16 v[56:71], a[112:115], v[76:79], 0
  v_mfma_f32_32x32x16_bf16 v[40:55], a[112:115], v[72:75], 0
  v_mfma_f32_32x32x16_bf16 v[24:39], a[0:3], v[76:79], 0
  v_mfma_f32_32x32x16_bf16 v[8:23], a[0:3], v[72:75], v[184:199]
  s_waitcnt vmcnt(24)
  v_mfma_f32_32x32x16_bf16 v[56:71], a[116:119], v[84:87], v[56:71]
  v_mfma_f32_32x32x16_bf16 v[40:55], a[116:119], v[80:83], v[40:55]
  v_mfma_f32_32x32x16_bf16 v[24:39], a[4:7], v[84:87], v[24:39]
  v_mfma_f32_32x32x16_bf16 v[8:23], a[4:7], v[80:83], v[8:23]
  s_waitcnt vmcnt(22)
  v_mfma_f32_32x32x16_bf16 v[56:71], a[120:123], v[92:95], v[56:71]
  v_mfma_f32_32x32x16_bf16 v[40:55], a[120:123], v[88:91], v[40:55]
  v_mfma_f32_32x32x16_bf16 v[24:39], a[8:11], v[92:95], v[24:39]
  v_mfma_f32_32x32x16_bf16 v[8:23], a[8:11], v[88:91], v[8:23]
  s_waitcnt vmcnt(20)
  v_mfma_f32_32x32x16_bf16 v[56:71], a[124:127], v[100:103], v[56:71]
  v_mfma_f32_32x32x16_bf16 v[40:55], a[124:127], v[96:99], v[40:55]
  v_mfma_f32_32x32x16_bf16 v[24:39], a[12:15], v[100:103], v[24:39]
  v_mfma_f32_32x32x16_bf16 v[8:23], a[12:15], v[96:99], v[8:23]
  s_cmp_lg_u32 s3, 3
  s_cbranch_scc1 Lpolls_sequential_preLN__mha_block__dense_activation_silu__prompt_kernel_29
  s_mov_b64 exec, 0x3fff
  s_mov_b32 s50, 0
  s_waitcnt vmcnt(12)
  v_cmp_ne_u64 vcc, s[40:41], v[248:249]
  s_nop 4
  s_cbranch_vccz Lpollo_sequential_preLN__mha_block__dense_activation_silu__prompt_kernel_28
Lpoll_sequential_preLN__mha_block__dense_activation_silu__prompt_kernel_27:
  s_cmp_lt_u32 s50, 6
  s_cselect_b32 s51, 262144, 0
  s_add_u32 s51, s51, s62
  buffer_load_dwordx2 v[248:249], v7, s[24:27], s51 offen sc1
  s_add_u32 s50, s50, 1
  s_waitcnt vmcnt(0)
  v_cmp_ne_u64 vcc, s[40:41], v[248:249]
  s_cmp_ge_u32 s50, 200000
  s_cbranch_scc1 Lpollo_sequential_preLN__mha_block__dense_activation_silu__prompt_kernel_28
  s_nop 2
  s_cbranch_vccnz Lpoll_sequential_preLN__mha_block__dense_activation_silu__prompt_kernel_27
Lpollo_sequential_preLN__mha_block__dense_activation_silu__prompt_kernel_28:
  s_mov_b64 exec, -1
Lpolls_sequential_preLN__mha_block__dense_activation_silu__prompt_kernel_29:
  s_barrier
  buffer_load_dwordx4 v[224:227], v3, s[24:27], s64 offen offset:0 sc1
  buffer_load_dwordx4 v[228:231], v3, s[24:27], s71 offen offset:0 sc1
  buffer_load_dwordx4 v[232:235], v3, s[24:27], s65 offen offset:0 sc1
  buffer_load_dwordx4 v[236:239], v3, s[24:27], s72 offen offset:0 sc1
  buffer_load_dwordx4 v[200:203], v3, s[24:27], s66 offen offset:0 sc1
  buffer_load_dwordx4 v[204:207], v3, s[24:27], s73 offen offset:0 sc1
  s_cmp_lg_u32 s3, 3
  s_cbranch_scc1 Lc3e_sequential_preLN__mha_block__dense_activation_silu__prompt_kernel_30
  s_mov_b64 exec, 0x3fff
  s_add_u32 s51, s15, 262144
  buffer_load_dwordx2 v[248:249], v7, s[24:27], s51 offen sc1
  s_mov_b64 exec, -1
Lc3e_sequential_preLN__mha_block__dense_activation_silu__prompt_kernel_30:
  buffer_load_dwordx4 v[208:211], v3, s[24:27], s67 offen offset:0 sc1
  buffer_load_dwordx4 v[212:215], v3, s[24:27], s74 offen offset:0 sc1
  buffer_load_dwordx4 v[240:243], v3, s[24:27], s68 offen offset:0 sc1
  buffer_load_dwordx4 v[244:247], v3, s[24:27], s75 offen offset:0 sc1
  buffer_load_dwordx4 v[72:75], v3, s[24:27], s69 offen offset:0 sc1
  buffer_load_dwordx4 v[76:79], v3, s[24:27], s8 offen offset:0 sc1
  buffer_load_dwordx4 v[80:83], v3, s[24:27], s70 offen offset:0 sc1
  buffer_load_dwordx4 v[84:87], v3, s[24:27], s9 offen offset:0 sc1
  s_waitcnt vmcnt(32)
  v_mfma_f32_32x32x16_bf16 v[56:71], a[128:131], v[108:111], v[56:71]
  v_mfma_f32_32x32x16_bf16 v[40:55], a[128:131], v[104:107], v[40:55]
  v_mfma_f32_32x32x16_bf16 v[24:39], a[16:19], v[108:111], v[24:39]
  v_mfma_f32_32x32x16_bf16 v[8:23], a[16:19], v[104:107], v[8:23]
  s_waitcnt vmcnt(30)
  v_mfma_f32_32x32x16_bf16 v[56:71], a[132:135], v[116:119], v[56:71]
  v_mfma_f32_32x32x16_bf16 v[40:55], a[132:135], v[112:115], v[40:55]
  v_mfma_f32_32x32x16_bf16 v[24:39], a[20:23], v[116:119], v[24:39]
  v_mfma_f32_32x32x16_bf16 v[8:23], a[20:23], v[112:115], v[8:23]
  s_waitcnt vmcnt(28)
  v_mfma_f32_32x32x16_bf16 v[56:71], a[136:139], v[124:127], v[56:71]
  v_mfma_f32_32x32x16_bf16 v[40:55], a[136:139], v[120:123], v[40:55]
  v_mfma_f32_32x32x16_bf16 v[24:39], a[24:27], v[124:127], v[24:39]
  v_mfma_f32_32x32x16_bf16 v[8:23], a[24:27], v[120:123], v[8:23]
  s_waitcnt vmcnt(26)
  v_mfma_f32_32x32x16_bf16 v[56:71], a[140:143], v[132:135], v[56:71]
  v_mfma_f32_32x32x16_bf16 v[40:55], a[140:143], v[128:131], v[40:55]
  v_mfma_f32_32x32x16_bf16 v[24:39], a[28:31], v[132:135], v[24:39]
  v_mfma_f32_32x32x16_bf16 v[8:23], a[28:31], v[128:131], v[8:23]
  s_waitcnt vmcnt(24)
  v_mfma_f32_32x32x16_bf16 v[56:71], a[144:147], v[140:143], v[56:71]
  v_mfma_f32_32x32x16_bf16 v[40:55], a[144:147], v[136:139], v[40:55]
  v_mfma_f32_32x32x16_bf16 v[24:39], a[32:35], v[140:143], v[24:39]
  v_mfma_f32_32x32x16_bf16 v[8:23], a[32:35], v[136:139], v[8:23]
  s_waitcnt vmcnt(22)
  v_mfma_f32_32x32x16_bf16 v[56:71], a[148:151], v[148:151], v[56:71]
  v_mfma_f32_32x32x16_bf16 v[40:55], a[148:151], v[144:147], v[40:55]
  v_mfma_f32_32x32x16_bf16 v[24:39], a[36:39], v[148:151], v[24:39]
  v_mfma_f32_32x32x16_bf16 v[8:23], a[36:39], v[144:147], v[8:23]
  s_cmp_lg_u32 s3, 3
  s_cbranch_scc1 Lpolls_sequential_preLN__mha_block__dense_activation_silu__prompt_kernel_33
  s_mov_b64 exec, 0x3fff
  s_mov_b32 s50, 0
  s_waitcnt vmcnt(8)
  v_cmp_ne_u64 vcc, s[40:41], v[248:249]
  s_nop 4
  s_cbranch_vccz Lpollo_sequential_preLN__mha_block__dense_activation_silu__prompt_kernel_32
Lpoll_sequential_preLN__mha_block__dense_activation_silu__prompt_kernel_31:
  s_cmp_lt_u32 s50, 6
  s_cselect_b32 s51, 262144, 0
  s_add_u32 s51, s51, s15
  buffer_load_dwordx2 v[248:249], v7, s[24:27], s51 offen sc1
  s_add_u32 s50, s50, 1
  s_waitcnt vmcnt(0)
  v_cmp_ne_u64 vcc, s[40:41], v[248:249]
  s_cmp_ge_u32 s50, 200000
  s_cbranch_scc1 Lpollo_sequential_preLN__mha_block__dense_activation_silu__prompt_kernel_32
  s_nop 2
  s_cbranch_vccnz Lpoll_sequential_preLN__mha_block__dense_activation_silu__prompt_kernel_31
Lpollo_sequential_preLN__mha_block__dense_activation_silu__prompt_kernel_32:
  s_mov_b64 exec, -1
Lpolls_sequential_preLN__mha_block__dense_activation_silu__prompt_kernel_33:
  s_barrier
  buffer_load_dwordx4 v[88:91], v3, s[24:27], s64 offen offset:2048 sc1
  buffer_load_dwordx4 v[92:95], v3, s[24:27], s71 offen offset:2048 sc1
  buffer_load_dwordx4 v[96:99], v3, s[24:27], s65 offen offset:2048 sc1
  buffer_load_dwordx4 v[100:103], v3, s[24:27], s72 offen offset:2048 sc1
  buffer_load_dwordx4 v[104:107], v3, s[24:27], s66 offen offset:2048 sc1
  buffer_load_dwordx4 v[108:111], v3, s[24:27], s73 offen offset:2048 sc1
  buffer_load_dwordx4 v[112:115], v3, s[24:27], s67 offen offset:2048 sc1
  buffer_load_dwordx4 v[116:119], v3, s[24:27], s74 offen offset:2048 sc1
  buffer_load_dwordx4 v[120:123], v3, s[24:27], s68 offen offset:2048 sc1
  buffer_load_dwordx4 v[124:127], v3, s[24:27], s75 offen offset:2048 sc1
  buffer_load_dwordx4 v[128:131], v3, s[24:27], s69 offen offset:2048 sc1
  buffer_load_dwordx4 v[132:135], v3, s[24:27], s8 offen offset:2048 sc1
  buffer_load_dwordx4 v[136:139], v3, s[24:27], s70 offen offset:2048 sc1
  buffer_load_dwordx4 v[140:143], v3, s[24:27], s9 offen offset:2048 sc1
  s_waitcnt vmcnt(34)
  v_mfma_f32_32x32x16_bf16 v[56:71], a[152:155], v[156:159], v[56:71]
  v_mfma_f32_32x32x16_bf16 v[40:55], a[152:155], v[152:155], v[40:55]
  v_mfma_f32_32x32x16_bf16 v[24:39], a[40:43], v[156:159], v[24:39]
  v_mfma_f32_32x32x16_bf16 v[8:23], a[40:43], v[152:155], v[8:23]
  s_waitcnt vmcnt(32)
  v_mfma_f32_32x32x16_bf16 v[56:71], a[156:159], v[164:167], v[56:71]
  v_mfma_f32_32x32x16_bf16 v[40:55], a[156:159], v[160:163], v[40:55]
  v_mfma_f32_32x32x16_bf16 v[24:39], a[44:47], v[164:167], v[24:39]
  v_mfma_f32_32x32x16_bf16 v[8:23], a[44:47], v[160:163], v[8:23]
  s_waitcnt vmcnt(30)
  v_mfma_f32_32x32x16_bf16 v[56:71], a[160:163], v[172:175], v[56:71]
  v_mfma_f32_32x32x16_bf16 v[40:55], a[160:163], v[168:171], v[40:55]
  v_mfma_f32_32x32x16_bf16 v[24:39], a[48:51], v[172:175], v[24:39]
  v_mfma_f32_32x32x16_bf16 v[8:23], a[48:51], v[168:171], v[8:23]
  s_waitcnt vmcnt(28)
  v_mfma_f32_32x32x16_bf16 v[56:71], a[164:167], v[180:183], v[56:71]
  v_mfma_f32_32x32x16_bf16 v[40:55], a[164:167], v[176:179], v[40:55]
  v_mfma_f32_32x32x16_bf16 v[24:39], a[52:55], v[180:183], v[24:39]
  v_mfma_f32_32x32x16_bf16 v[8:23], a[52:55], v[176:179], v[8:23]
  s_waitcnt vmcnt(26)
  v_mfma_f32_32x32x16_bf16 v[56:71], a[168:171], v[228:231], v[56:71]
  v_mfma_f32_32x32x16_bf16 v[40:55], a[168:171], v[224:227], v[40:55]
  v_mfma_f32_32x32x16_bf16 v[24:39], a[56:59], v[228:231], v[24:39]
  v_mfma_f32_32x32x16_bf16 v[8:23], a[56:59], v[224:227], v[8:23]
  s_waitcnt vmcnt(24)
  v_mfma_f32_32x32x16_bf16 v[56:71], a[172:175], v[236:239], v[56:71]
  v_mfma_f32_32x32x16_bf16 v[40:55], a[172:175], v[232:235], v[40:55]
  v_mfma_f32_32x32x16_bf16 v[24:39], a[60:63], v[236:239], v[24:39]
  v_mfma_f32_32x32x16_bf16 v[8:23], a[60:63], v[232:235], v[8:23]
  s_waitcnt vmcnt(22)
  v_mfma_f32_32x32x16_bf16 v[56:71], a[176:179], v[204:207], v[56:71]
  v_mfma_f32_32x32x16_bf16 v[40:55], a[176:179], v[200:203], v[40:55]
  v_mfma_f32_32x32x16_bf16 v[24:39], a[64:67], v[204:207], v[24:39]
  v_mfma_f32_32x32x16_bf16 v[8:23], a[64:67], v[200:203], v[8:23]
  s_waitcnt vmcnt(20)
  v_mfma_f32_32x32x16_bf16 v[56:71], a[180:183], v[212:215], v[56:71]
  v_mfma_f32_32x32x16_bf16 v[40:55], a[180:183], v[208:211], v[40:55]
  v_mfma_f32_32x32x16_bf16 v[24:39], a[68:71], v[212:215], v[24:39]
  v_mfma_f32_32x32x16_bf16 v[8:23], a[68:71], v[208:211], v[8:23]
  s_waitcnt vmcnt(18)
  v_mfma_f32_32x32x16_bf16 v[56:71], a[184:187], v[244:247], v[56:71]
  v_mfma_f32_32x32x16_bf16 v[40:55], a[184:187], v[240:243], v[40:55]
  v_mfma_f32_32x32x16_bf16 v[24:39], a[72:75], v[244:247], v[24:39]
  v_mfma_f32_32x32x16_bf16 v[8:23], a[72:75], v[240:243], v[8:23]
  s_waitcnt vmcnt(16)
  v_mfma_f32_32x32x16_bf16 v[56:71], a[188:191], v[76:79], v[56:71]
  v_mfma_f32_32x32x16_bf16 v[40:55], a[188:191], v[72:75], v[40:55]
  v_mfma_f32_32x32x16_bf16 v[24:39], a[76:79], v[76:79], v[24:39]
  v_mfma_f32_32x32x16_bf16 v[8:23], a[76:79], v[72:75], v[8:23]
  s_waitcnt vmcnt(14)
  v_mfma_f32_32x32x16_bf16 v[56:71], a[192:195], v[84:87], v[56:71]
  v_mfma_f32_32x32x16_bf16 v[40:55], a[192:195], v[80:83], v[40:55]
  v_mfma_f32_32x32x16_bf16 v[24:39], a[80:83], v[84:87], v[24:39]
  v_mfma_f32_32x32x16_bf16 v[8:23], a[80:83], v[80:83], v[8:23]
  s_waitcnt vmcnt(12)
  v_mfma_f32_32x32x16_bf16 v[56:71], a[196:199], v[92:95], v[56:71]
  v_mfma_f32_32x32x16_bf16 v[40:55], a[196:199], v[88:91], v[40:55]
  v_mfma_f32_32x32x16_bf16 v[24:39], a[84:87], v[92:95], v[24:39]
  v_mfma_f32_32x32x16_bf16 v[8:23], a[84:87], v[88:91], v[8:23]
  s_waitcnt vmcnt(10)
  v_mfma_f32_32x32x16_bf16 v[56:71], a[200:203], v[100:103], v[56:71]
  v_mfma_f32_32x32x16_bf16 v[40:55], a[200:203], v[96:99], v[40:55]
  v_mfma_f32_32x32x16_bf16 v[24:39], a[88:91], v[100:103], v[24:39]
  v_mfma_f32_32x32x16_bf16 v[8:23], a[88:91], v[96:99], v[8:23]
  s_waitcnt vmcnt(8)
  v_mfma_f32_32x32x16_bf16 v[56:71], a[204:207], v[108:111], v[56:71]
  v_mfma_f32_32x32x16_bf16 v[40:55], a[204:207], v[104:107], v[40:55]
  v_mfma_f32_32x32x16_bf16 v[24:39], a[92:95], v[108:111], v[24:39]
  v_mfma_f32_32x32x16_bf16 v[8:23], a[92:95], v[104:107], v[8:23]
  s_waitcnt vmcnt(6)
  v_mfma_f32_32x32x16_bf16 v[56:71], a[208:211], v[116:119], v[56:71]
  v_mfma_f32_32x32x16_bf16 v[40:55], a[208:211], v[112:115], v[40:55]
  v_mfma_f32_32x32x16_bf16 v[24:39], a[96:99], v[116:119], v[24:39]
  v_mfma_f32_32x32x16_bf16 v[8:23], a[96:99], v[112:115], v[8:23]
  s_waitcnt vmcnt(4)
  v_mfma_f32_32x32x16_bf16 v[56:71], a[212:215], v[124:127], v[56:71]
  v_mfma_f32_32x32x16_bf16 v[40:55], a[212:215], v[120:123], v[40:55]
  v_mfma_f32_32x32x16_bf16 v[24:39], a[100:103], v[124:127], v[24:39]
  v_mfma_f32_32x32x16_bf16 v[8:23], a[100:103], v[120:123], v[8:23]
  s_waitcnt vmcnt(2)
  v_mfma_f32_32x32x16_bf16 v[56:71], a[216:219], v[132:135], v[56:71]
  v_mfma_f32_32x32x16_bf16 v[40:55], a[216:219], v[128:131], v[40:55]
  v_mfma_f32_32x32x16_bf16 v[24:39], a[104:107], v[132:135], v[24:39]
  v_mfma_f32_32x32x16_bf16 v[8:23], a[104:107], v[128:131], v[8:23]
  s_waitcnt vmcnt(0)
  v_mfma_f32_32x32x16_bf16 v[56:71], a[220:223], v[140:143], v[56:71]
  v_mfma_f32_32x32x16_bf16 v[40:55], a[220:223], v[136:139], v[40:55]
  v_mfma_f32_32x32x16_bf16 v[24:39], a[108:111], v[140:143], v[24:39]
  v_mfma_f32_32x32x16_bf16 v[8:23], a[108:111], v[136:139], v[8:23]
  v_xor_b32 v4, 12288, v5
  s_nop 7
  ds_write_b128 v4, v[56:59] offset:32768
  ds_write_b128 v4, v[60:63] offset:33792
  ds_write_b128 v4, v[64:67] offset:34816
  ds_write_b128 v4, v[68:71] offset:35840
  v_xor_b32 v4, 8192, v5
  ds_write_b128 v4, v[40:43] offset:16384
  ds_write_b128 v4, v[44:47] offset:17408
  ds_write_b128 v4, v[48:51] offset:18432
  ds_write_b128 v4, v[52:55] offset:19456
  v_xor_b32 v4, 4096, v5
  ds_write_b128 v4, v[24:27] offset:0
  ds_write_b128 v4, v[28:31] offset:1024
  ds_write_b128 v4, v[32:35] offset:2048
  ds_write_b128 v4, v[36:39] offset:3072
  s_waitcnt lgkmcnt(0)
  s_barrier
  ds_read_b128 v[24:27], v5 offset:0
  ds_read_b128 v[28:31], v5 offset:1024
  ds_read_b128 v[32:35], v5 offset:2048
  ds_read_b128 v[36:39], v5 offset:3072
  ds_read_b128 v[40:43], v5 offset:16384
  ds_read_b128 v[44:47], v5 offset:17408
  ds_read_b128 v[48:51], v5 offset:18432
  ds_read_b128 v[52:55], v5 offset:19456
  ds_read_b128 v[56:59], v5 offset:32768
  ds_read_b128 v[60:63], v5 offset:33792
  ds_read_b128 v[64:67], v5 offset:34816
  ds_read_b128 v[68:71], v5 offset:35840
  s_waitcnt lgkmcnt(11)
  v_pk_add_f32 v[8:9], v[8:9], v[24:25]
  v_pk_add_f32 v[10:11], v[10:11], v[26:27]
  s_waitcnt lgkmcnt(10)
  v_pk_add_f32 v[12:13], v[12:13], v[28:29]
  v_pk_add_f32 v[14:15], v[14:15], v[30:31]
  s_waitcnt lgkmcnt(9)
  v_pk_add_f32 v[16:17], v[16:17], v[32:33]
  v_pk_add_f32 v[18:19], v[18:19], v[34:35]
  s_waitcnt lgkmcnt(8)
  v_pk_add_f32 v[20:21], v[20:21], v[36:37]
  v_pk_add_f32 v[22:23], v[22:23], v[38:39]
  s_waitcnt lgkmcnt(7)
  v_pk_add_f32 v[8:9], v[8:9], v[40:41]
  v_pk_add_f32 v[10:11], v[10:11], v[42:43]
  s_waitcnt lgkmcnt(6)
  v_pk_add_f32 v[12:13], v[12:13], v[44:45]
  v_pk_add_f32 v[14:15], v[14:15], v[46:47]
  s_waitcnt lgkmcnt(5)
  v_pk_add_f32 v[16:17], v[16:17], v[48:49]
  v_pk_add_f32 v[18:19], v[18:19], v[50:51]
  s_waitcnt lgkmcnt(4)
  v_pk_add_f32 v[20:21], v[20:21], v[52:53]
  v_pk_add_f32 v[22:23], v[22:23], v[54:55]
  s_waitcnt lgkmcnt(3)
  v_pk_add_f32 v[8:9], v[8:9], v[56:57]
  v_pk_add_f32 v[10:11], v[10:11], v[58:59]
  s_waitcnt lgkmcnt(2)
  v_pk_add_f32 v[12:13], v[12:13], v[60:61]
  v_pk_add_f32 v[14:15], v[14:15], v[62:63]
  s_waitcnt lgkmcnt(1)
  v_pk_add_f32 v[16:17], v[16:17], v[64:65]
  v_pk_add_f32 v[18:19], v[18:19], v[66:67]
  s_waitcnt lgkmcnt(0)
  v_pk_add_f32 v[20:21], v[20:21], v[68:69]
  v_pk_add_f32 v[22:23], v[22:23], v[70:71]
  v_cvt_pk_bf16_f32 v216, v8, v9
  v_cvt_pk_bf16_f32 v217, v10, v11
  v_cvt_pk_bf16_f32 v218, v12, v13
  v_cvt_pk_bf16_f32 v219, v14, v15
  s_nop 0
  v_permlane32_swap_b32 v216, v218
  v_permlane32_swap_b32 v217, v219
  buffer_store_dwordx4 v[216:219], v6, s[28:31], s11 offen offset:0
  v_cvt_pk_bf16_f32 v220, v16, v17
  v_cvt_pk_bf16_f32 v221, v18, v19
  v_cvt_pk_bf16_f32 v222, v20, v21
  v_cvt_pk_bf16_f32 v223, v22, v23
  s_nop 0
  v_permlane32_swap_b32 v220, v222
  v_permlane32_swap_b32 v221, v223
  buffer_store_dwordx4 v[220:223], v6, s[28:31], s11 offen offset:32
L_end:
  s_endpgm
L_attn_slow:
  v_mov_b32 v188, 0xff7fffff
  s_mov_b32 s56, s49
  s_mov_b32 s50, 0
  v_bfi_b32 v14, v3, 0, v14
  v_bfi_b32 v15, v3, 0, v15
L_attn_p1:
  buffer_load_dwordx4 v[144:147], v2, s[24:27], s56 offen sc1
  buffer_load_dwordx4 v[148:151], v2, s[24:27], s56 offen offset:1024 sc1
  s_add_u32 s56, s56, 4096
  s_waitcnt vmcnt(0)
  v_mfma_f32_32x32x16_bf16 v[120:135], v[144:147], v[8:11], 0
  v_mfma_f32_32x32x16_bf16 v[120:135], v[148:151], v[12:15], v[120:135]
  s_nop 11
  v_max_f32 v188, v188, v120
  v_max_f32 v188, v188, v121
  v_max_f32 v188, v188, v122
  v_max_f32 v188, v188, v123
  v_max_f32 v188, v188, v124
  v_max_f32 v188, v188, v125
  v_max_f32 v188, v188, v126
  v_max_f32 v188, v188, v127
  v_max_f32 v188, v188, v128
  v_max_f32 v188, v188, v129
  v_max_f32 v188, v188, v130
  v_max_f32 v188, v188, v131
  v_max_f32 v188, v188, v132
  v_max_f32 v188, v188, v133
  v_max_f32 v188, v188, v134
  v_max_f32 v188, v188, v135
  s_add_u32 s50, s50, 1
  s_cmp_lt_u32 s50, 64
  s_cbranch_scc1 L_attn_p1
  v_mov_b32 v185, v188
  s_nop 1
  v_permlane32_swap_b32 v185, v188
  v_max_f32 v188, v188, v185
  v_sub_f32 v188, 0, v188
  v_and_b32 v189, 0xffff0000, v188
  v_sub_f32 v188, v188, v189
  v_and_b32 v190, 0xffff0000, v188
  v_sub_f32 v188, v188, v190
  v_lshrrev_b32 v189, 16, v189
  v_or_b32 v189, v189, v190
  v_lshrrev_b32 v188, 16, v188
  v_bfi_b32 v14, v3, v189, v14
  v_bfi_b32 v15, v3, v188, v15
  s_mov_b32 s56, s49
  s_mov_b32 s50, 0
  v_mov_b32 v40, 0
  v_mov_b32 v41, 0
  v_mov_b32 v42, 0
  v_mov_b32 v43, 0
  v_mov_b32 v44, 0
  v_mov_b32 v45, 0
  v_mov_b32 v46, 0
  v_mov_b32 v47, 0
  v_mov_b32 v48, 0
  v_mov_b32 v49, 0
  v_mov_b32 v50, 0
  v_mov_b32 v51, 0
  v_mov_b32 v52, 0
  v_mov_b32 v53, 0
  v_mov_b32 v54, 0
  v_mov_b32 v55, 0
L_attn_p2:
  buffer_load_dwordx4 v[144:147], v2, s[24:27], s56 offen offset:0 sc1
  buffer_load_dwordx4 v[148:151], v2, s[24:27], s56 offen offset:1024 sc1
  buffer_load_dwordx4 v[152:155], v2, s[24:27], s56 offen offset:2048 sc1
  buffer_load_dwordx4 v[156:159], v2, s[24:27], s56 offen offset:3072 sc1
  s_add_u32 s56, s56, 4096
  s_waitcnt vmcnt(0)
  v_mfma_f32_32x32x16_bf16 v[120:135], v[144:147], v[8:11], 0
  v_mfma_f32_32x32x16_bf16 v[120:135], v[148:151], v[12:15], v[120:135]
  s_nop 11
  v_exp_f32 v120, v120
  v_exp_f32 v121, v121
  v_exp_f32 v122, v122
  v_exp_f32 v123, v123
  v_exp_f32 v124, v124
  v_exp_f32 v125, v125
  v_exp_f32 v126, v126
  v_exp_f32 v127, v127
  v_exp_f32 v128, v128
  v_exp_f32 v129, v129
  v_exp_f32 v130, v130
  v_exp_f32 v131, v131
  v_exp_f32 v132, v132
  v_exp_f32 v133, v133
  v_exp_f32 v134, v134
  v_exp_f32 v135, v135
  v_cvt_pk_bf16_f32 v136, v120, v121
  v_cvt_pk_bf16_f32 v137, v122, v123
  v_cvt_pk_bf16_f32 v138, v124, v125
  v_cvt_pk_bf16_f32 v139, v126, v127
  v_cvt_pk_bf16_f32 v140, v128, v129
  v_cvt_pk_bf16_f32 v141, v130, v131
  v_cvt_pk_bf16_f32 v142, v132, v133
  v_cvt_pk_bf16_f32 v143, v134, v135
  v_mfma_f32_32x32x16_bf16 v[40:55], v[152:155], v[136:139], v[40:55]
  s_nop 0
  v_mfma_f32_32x32x16_bf16 v[40:55], v[156:159], v[140:143], v[40:55]
  s_add_u32 s50, s50, 1
  s_cmp_lt_u32 s50, 64
  s_cbranch_scc1 L_attn_p2
  s_nop 8
  v_mov_b32 v104, v52
  v_mov_b32 v105, v52
  s_nop 1
  v_permlane32_swap_b32 v105, v104
  v_rcp_f32 v104, v104
  s_branch L_attn_store
L_code_end:
  s_endpgm
.section .rodata,"a"
.p2align 6
.amdhsa_kernel sequential_preLN__mha_block__dense_activation_silu__prompt_kernel
  .amdhsa_next_free_vgpr 512
  .amdhsa_next_free_sgpr 76
  .amdhsa_accum_offset 256
  .amdhsa_group_segment_fixed_size 0
  .amdhsa_kernarg_size 72
  .amdhsa_user_sgpr_count 2
  .amdhsa_user_sgpr_kernarg_segment_ptr 1
  .amdhsa_system_sgpr_workgroup_id_x 1
.end_amdhsa_kernel
```
